```python
import torch

def _softmax(x, axis=-1):
    return torch.softmax(x, dim=axis)
def _gelu(x):
    return torch.nn.functional.gelu(x, approximate="tanh")
def _silu(x):
    return torch.nn.functional.silu(x)
def _sigmoid(x):
    return torch.sigmoid(x)
def _layernorm(x, axis=-1, eps=1e-5):
    m = x.mean(dim=axis, keepdim=True)
    v = x.var(dim=axis, keepdim=True, unbiased=False)
    return (x - m) / torch.sqrt(v + eps)
def _scatter_add(tgt, idx, src, axis=0):
    return tgt.clone().index_add_(axis, idx, src)
def _segment_sum(src, seg, n):
    out = torch.zeros((n,) + src.shape[1:], dtype=src.dtype)
    return out.index_add_(0, seg, src)
def _pad(x, pw):
    flat = tuple(v for pair in reversed(pw) for v in pair)
    return torch.nn.functional.pad(x, flat)

kernel_name = 'recurrent_scan__grouped_kv_mqa__geglu_ffn__prompt'

def setup_inputs():

    _w = (lambda a: (lambda t: t.to(torch.bfloat16) if t.is_floating_point() else t)(torch.as_tensor(a)))
    def _A_setup():
        B, S, D, H = 1, 2048, 512, 32
        Dh = D // H
        return {
            "x": _w((lambda *s: torch.randn(*s, dtype=torch.bfloat16) * 0.05)(B, S, D)),
            "wq": _w((lambda *s: torch.randn(*s, dtype=torch.bfloat16) * 0.05)(D, H * Dh)),
            "wk": _w((lambda *s: torch.randn(*s, dtype=torch.bfloat16) * 0.05)(D, Dh)),
            "wv": _w((lambda *s: torch.randn(*s, dtype=torch.bfloat16) * 0.05)(D, Dh)),
            "wo": _w((lambda *s: torch.randn(*s, dtype=torch.bfloat16) * 0.05)(H * Dh, D)),
        }
    _A_in = _A_setup()

    def _B_setup():
        B, S, D, F = 1, 2048, 512, 1376
        return {
            "x": _w((lambda *s: torch.randn(*s, dtype=torch.bfloat16) * 0.05)(B, S, D)),
            "w_gate": _w((lambda *s: torch.randn(*s, dtype=torch.bfloat16) * 0.05)(D, F)),
            "w_up": _w((lambda *s: torch.randn(*s, dtype=torch.bfloat16) * 0.05)(D, F)),
            "w_down": _w((lambda *s: torch.randn(*s, dtype=torch.bfloat16) * 0.05)(F, D)),
        }
    _B_in = _B_setup()

    return {
        "A_x": _A_in["x"],
        "A_wq": _A_in["wq"],
        "A_wk": _A_in["wk"],
        "A_wv": _A_in["wv"],
        "A_wo": _A_in["wo"],
        "B_x": _B_in["x"],
        "B_w_gate": _B_in["w_gate"],
        "B_w_up": _B_in["w_up"],
        "B_w_down": _B_in["w_down"],
    }

def reference(A_x, A_wq, A_wk, A_wv, A_wo, B_x, B_w_gate, B_w_up, B_w_down):
    def _A_ref(x, wq, wk, wv, wo):
        B, S, D = x.shape
        H = 32
        Dh = D // H
        q = (lambda x, *d: x.permute(*d))((x @ wq).reshape(B, S, H, Dh), 0, 2, 1, 3)
        k = x @ wk
        v = x @ wv
        scores = torch.einsum("bhqd,bkd->bhqk", q, k) * (Dh ** -0.5)
        p = _softmax(scores, axis=-1)
        o = torch.einsum("bhqk,bkd->bhqd", p, v)
        return (lambda x, *d: x.permute(*d))(o, 0, 2, 1, 3).reshape(B, S, H * Dh) @ wo

    def _B_ref(x, w_gate, w_up, w_down):
        return (_gelu(x @ w_gate) * (x @ w_up)) @ w_down

    x = A_x
    xn = _layernorm(x, axis=-1)
    s = _A_ref(xn, A_wq, A_wk, A_wv, A_wo)
    g = _silu(_B_ref(xn, B_w_gate, B_w_up, B_w_down))
    return x + s * g
```

```asm
; @launch grid=(256,1,1) block=(512,1,1) lds=161792
.amdgcn_target "amdgcn-amd-amdhsa--gfx950"
.text
.globl recurrent_scan__grouped_kv_mqa__geglu_ffn__prompt_kernel
.p2align 12
.p2align 8
.type recurrent_scan__grouped_kv_mqa__geglu_ffn__prompt_kernel,@function
recurrent_scan__grouped_kv_mqa__geglu_ffn__prompt_kernel:
    s_cmp_ge_u32 s2, 256
    s_cbranch_scc1 fk_end
    s_load_dwordx16 s[4:19], s[0:1], 0
    s_load_dwordx8 s[20:27], s[0:1], 64
    v_lshrrev_b32 v2, 6, v0
    v_and_b32 v254, 63, v0
    v_readfirstlane_b32 s56, v2
    v_mov_b32 v9, 159744
    v_mov_b32 v12, 0
    v_mov_b32 v13, 0
    v_mov_b32 v14, 0
    v_mov_b32 v15, 0
    ds_write_b128 v9, v[12:15]
    ds_write_b32 v9, v12 offset:16
    s_and_b32 s59, s2, 7
    s_lshr_b32 s60, s2, 3
    s_lshr_b32 s58, s60, 3
    s_and_b32 s62, s60, 7
    s_lshl_b32 s57, s59, 3
    s_add_u32 s57, s57, s62
    s_and_b32 s63, s56, 3
    s_lshl_b32 s92, s57, 7
    s_add_u32 s92, s92, s63
    s_lshl_b32 s93, s63, 4
    s_add_u32 s93, s93, s58
    s_mul_i32 s94, s63, 136
    s_lshl_b32 s95, s63, 4
    s_addk_i32 s95, 832
    s_and_b32 s45, s59, 3
    s_lshl_b32 s44, s45, 17
    s_cmp_ge_u32 s56, 4
    s_cselect_b32 s44, 0, s44
    s_cselect_b32 s92, s92, s93
    s_cselect_b32 s93, s94, s95
    s_cselect_b32 s94, 17, 64
    s_cselect_b32 s95, 1, 4
    s_cselect_b32 s96, 8, 8
    s_cselect_b32 s63, 0, 2
    s_lshl_b32 s92, s92, 8
    s_lshl_b32 s93, s93, 6
    s_lshl_b32 s94, s94, 6
    s_lshl_b32 s95, s95, 12
    v_lshrrev_b32 v7, 4, v254
    v_lshlrev_b32 v8, s63, v7
    v_and_b32 v6, 15, v254
    v_xor_b32 v8, v8, v6
    v_lshlrev_b32 v6, 10, v7
    v_lshl_add_u32 v6, v8, 4, v6
    s_mov_b32 m0, s93
    s_mov_b32 s62, s92
    s_mov_b32 s34, 0x80000
    s_mov_b32 s35, 0x00020000
    s_waitcnt lgkmcnt(0)
    s_cmp_ge_u32 s56, 4
    s_cselect_b32 s32, s4, s6
    s_cselect_b32 s33, s5, s7
    s_cselect_b32 s34, 0x200000, s34
    s_cbranch_scc1 fk_dma0
    s_load_dword s85, s[6:7], 0
    s_load_dword s85, s[16:17], 0
    s_load_dword s85, s[18:19], 0
    s_barrier
fk_dma0:
    s_xor_b32 s63, s62, s44
    buffer_load_dwordx4 v6, s[32:35], s63 offen lds
    s_add_u32 s62, s62, s95
    s_add_u32 m0, m0, s94
    s_sub_u32 s96, s96, 1
    s_cmp_lg_u32 s96, 0
    s_cbranch_scc1 fk_dma0
    v_lshlrev_b32 v255, 4, v254
    s_cmp_lt_u32 s56, 4
    s_cbranch_scc1 fk_qentry
    s_load_dword s61, s[26:27], 0
    s_sub_u32 s92, s56, 4
    s_cmp_eq_u32 s58, 0
    s_cselect_b32 s36, s8, s10
    s_cselect_b32 s37, s9, s11
    s_cmp_lt_u32 s58, 2
    s_cselect_b32 s38, 16384, 0
    s_mov_b32 s39, 0x00020000
    s_lshl_b32 s62, s92, 12
    s_add_u32 m0, s62, 34816
    v_mov_b32 v242, 159744
    buffer_load_dwordx4 v255, s[36:39], s62 offen offset:0 lds
    buffer_load_dwordx4 v255, s[36:39], s62 offen offset:1024 lds
    buffer_load_dwordx4 v255, s[36:39], s62 offen offset:2048 lds
    buffer_load_dwordx4 v255, s[36:39], s62 offen offset:3072 lds
    s_barrier
    v_mov_b32 v243, 1
    s_mov_b32 s28, s26
    s_mov_b32 s29, s27
    s_mov_b32 s30, 0x1100000
    s_mov_b32 s31, 0x00020000
    s_setprio 2
    v_and_b32 v3, 31, v254
    v_lshrrev_b32 v4, 5, v254
    v_lshlrev_b32 v8, 6, v3
    v_add_u32 v8, 51200, v8
    s_lshl_b32 s63, s92, 4
    v_lshl_add_u32 v9, v4, 3, v8
    v_add_u32 v9, s63, v9
    s_xor_b32 s63, s92, s45
    s_lshl_b32 s63, s63, 13
    v_add_u32 v7, s63, v255
    v_bfe_u32 v2, v254, 2, 2
    v_lshl_add_u32 v2, v4, 3, v2
    v_lshlrev_b32 v6, 5, v2
    v_and_b32 v2, 3, v254
    v_lshl_add_u32 v6, v2, 3, v6
    v_add_u32 v6, s62, v6
    v_lshrrev_b32 v2, 2, v3
    v_mul_u32_u24 v5, 1088, v2
    v_and_b32 v2, 3, v3
    v_lshl_add_u32 v5, v2, 8, v5
    s_mul_i32 s63, s92, 8704
    v_add_u32 v5, s63, v5
    v_xor_b32 v2, v2, v4
    v_lshl_add_u32 v112, v2, 4, v5
    v_xor_b32 v2, 2, v2
    v_lshl_add_u32 v113, v2, 4, v5
    s_waitcnt lgkmcnt(0)
    s_waitcnt vmcnt(4)
    ds_read_b128 v[16:19], v112 offset:0
    ds_read_b128 v[20:23], v113 offset:0
    ds_read_b128 v[24:27], v112 offset:64
    ds_read_b128 v[28:31], v113 offset:64
    ds_read_b128 v[32:35], v112 offset:128
    ds_read_b128 v[36:39], v113 offset:128
    ds_read_b128 v[40:43], v112 offset:192
    ds_read_b128 v[44:47], v113 offset:192
    s_waitcnt lgkmcnt(7)
    v_lshlrev_b32 v48, 16, v16
    v_and_b32 v49, 0xffff0000, v16
    v_lshlrev_b32 v50, 16, v17
    v_and_b32 v51, 0xffff0000, v17
    v_lshlrev_b32 v52, 16, v18
    v_and_b32 v53, 0xffff0000, v18
    v_lshlrev_b32 v54, 16, v19
    v_and_b32 v55, 0xffff0000, v19
    v_pk_add_f32 v[12:13], v[48:49], v[50:51]
    v_pk_add_f32 v[14:15], v[52:53], v[54:55]
    s_waitcnt lgkmcnt(6)
    v_lshlrev_b32 v56, 16, v20
    v_and_b32 v57, 0xffff0000, v20
    v_lshlrev_b32 v58, 16, v21
    v_and_b32 v59, 0xffff0000, v21
    v_lshlrev_b32 v60, 16, v22
    v_and_b32 v61, 0xffff0000, v22
    v_lshlrev_b32 v62, 16, v23
    v_and_b32 v63, 0xffff0000, v23
    v_pk_add_f32 v[12:13], v[12:13], v[56:57]
    v_pk_add_f32 v[14:15], v[14:15], v[58:59]
    v_pk_add_f32 v[12:13], v[12:13], v[60:61]
    v_pk_add_f32 v[14:15], v[14:15], v[62:63]
    s_waitcnt lgkmcnt(5)
    v_lshlrev_b32 v64, 16, v24
    v_and_b32 v65, 0xffff0000, v24
    v_lshlrev_b32 v66, 16, v25
    v_and_b32 v67, 0xffff0000, v25
    v_lshlrev_b32 v68, 16, v26
    v_and_b32 v69, 0xffff0000, v26
    v_lshlrev_b32 v70, 16, v27
    v_and_b32 v71, 0xffff0000, v27
    v_pk_add_f32 v[12:13], v[12:13], v[64:65]
    v_pk_add_f32 v[14:15], v[14:15], v[66:67]
    v_pk_add_f32 v[12:13], v[12:13], v[68:69]
    v_pk_add_f32 v[14:15], v[14:15], v[70:71]
    s_waitcnt lgkmcnt(4)
    v_lshlrev_b32 v72, 16, v28
    v_and_b32 v73, 0xffff0000, v28
    v_lshlrev_b32 v74, 16, v29
    v_and_b32 v75, 0xffff0000, v29
    v_lshlrev_b32 v76, 16, v30
    v_and_b32 v77, 0xffff0000, v30
    v_lshlrev_b32 v78, 16, v31
    v_and_b32 v79, 0xffff0000, v31
    v_pk_add_f32 v[12:13], v[12:13], v[72:73]
    v_pk_add_f32 v[14:15], v[14:15], v[74:75]
    v_pk_add_f32 v[12:13], v[12:13], v[76:77]
    v_pk_add_f32 v[14:15], v[14:15], v[78:79]
    s_waitcnt lgkmcnt(3)
    v_lshlrev_b32 v80, 16, v32
    v_and_b32 v81, 0xffff0000, v32
    v_lshlrev_b32 v82, 16, v33
    v_and_b32 v83, 0xffff0000, v33
    v_lshlrev_b32 v84, 16, v34
    v_and_b32 v85, 0xffff0000, v34
    v_lshlrev_b32 v86, 16, v35
    v_and_b32 v87, 0xffff0000, v35
    v_pk_add_f32 v[12:13], v[12:13], v[80:81]
    v_pk_add_f32 v[14:15], v[14:15], v[82:83]
    v_pk_add_f32 v[12:13], v[12:13], v[84:85]
    v_pk_add_f32 v[14:15], v[14:15], v[86:87]
    s_waitcnt lgkmcnt(2)
    v_lshlrev_b32 v88, 16, v36
    v_and_b32 v89, 0xffff0000, v36
    v_lshlrev_b32 v90, 16, v37
    v_and_b32 v91, 0xffff0000, v37
    v_lshlrev_b32 v92, 16, v38
    v_and_b32 v93, 0xffff0000, v38
    v_lshlrev_b32 v94, 16, v39
    v_and_b32 v95, 0xffff0000, v39
    v_pk_add_f32 v[12:13], v[12:13], v[88:89]
    v_pk_add_f32 v[14:15], v[14:15], v[90:91]
    v_pk_add_f32 v[12:13], v[12:13], v[92:93]
    v_pk_add_f32 v[14:15], v[14:15], v[94:95]
    s_waitcnt lgkmcnt(1)
    v_lshlrev_b32 v96, 16, v40
    v_and_b32 v97, 0xffff0000, v40
    v_lshlrev_b32 v98, 16, v41
    v_and_b32 v99, 0xffff0000, v41
    v_lshlrev_b32 v100, 16, v42
    v_and_b32 v101, 0xffff0000, v42
    v_lshlrev_b32 v102, 16, v43
    v_and_b32 v103, 0xffff0000, v43
    v_pk_add_f32 v[12:13], v[12:13], v[96:97]
    v_pk_add_f32 v[14:15], v[14:15], v[98:99]
    v_pk_add_f32 v[12:13], v[12:13], v[100:101]
    v_pk_add_f32 v[14:15], v[14:15], v[102:103]
    s_waitcnt lgkmcnt(0)
    v_lshlrev_b32 v104, 16, v44
    v_and_b32 v105, 0xffff0000, v44
    v_lshlrev_b32 v106, 16, v45
    v_and_b32 v107, 0xffff0000, v45
    v_lshlrev_b32 v108, 16, v46
    v_and_b32 v109, 0xffff0000, v46
    v_lshlrev_b32 v110, 16, v47
    v_and_b32 v111, 0xffff0000, v47
    v_pk_add_f32 v[12:13], v[12:13], v[104:105]
    v_pk_add_f32 v[14:15], v[14:15], v[106:107]
    v_pk_add_f32 v[12:13], v[12:13], v[108:109]
    v_pk_add_f32 v[14:15], v[14:15], v[110:111]
    v_pk_add_f32 v[12:13], v[12:13], v[14:15]
    v_add_f32 v10, v12, v13
    v_mul_f32 v10, 0x3c800000, v10
    v_pk_add_f32 v[48:49], v[48:49], v[10:11] op_sel_hi:[1,0] neg_lo:[0,1] neg_hi:[0,1]
    v_pk_add_f32 v[50:51], v[50:51], v[10:11] op_sel_hi:[1,0] neg_lo:[0,1] neg_hi:[0,1]
    v_pk_mul_f32 v[12:13], v[48:49], v[48:49]
    v_pk_add_f32 v[52:53], v[52:53], v[10:11] op_sel_hi:[1,0] neg_lo:[0,1] neg_hi:[0,1]
    v_pk_mul_f32 v[14:15], v[50:51], v[50:51]
    v_pk_add_f32 v[54:55], v[54:55], v[10:11] op_sel_hi:[1,0] neg_lo:[0,1] neg_hi:[0,1]
    v_pk_fma_f32 v[12:13], v[52:53], v[52:53], v[12:13]
    v_pk_add_f32 v[56:57], v[56:57], v[10:11] op_sel_hi:[1,0] neg_lo:[0,1] neg_hi:[0,1]
    v_pk_fma_f32 v[14:15], v[54:55], v[54:55], v[14:15]
    v_pk_add_f32 v[58:59], v[58:59], v[10:11] op_sel_hi:[1,0] neg_lo:[0,1] neg_hi:[0,1]
    v_pk_fma_f32 v[12:13], v[56:57], v[56:57], v[12:13]
    v_pk_add_f32 v[60:61], v[60:61], v[10:11] op_sel_hi:[1,0] neg_lo:[0,1] neg_hi:[0,1]
    v_pk_fma_f32 v[14:15], v[58:59], v[58:59], v[14:15]
    v_pk_add_f32 v[62:63], v[62:63], v[10:11] op_sel_hi:[1,0] neg_lo:[0,1] neg_hi:[0,1]
    v_pk_fma_f32 v[12:13], v[60:61], v[60:61], v[12:13]
    v_pk_add_f32 v[64:65], v[64:65], v[10:11] op_sel_hi:[1,0] neg_lo:[0,1] neg_hi:[0,1]
    v_pk_fma_f32 v[14:15], v[62:63], v[62:63], v[14:15]
    v_pk_add_f32 v[66:67], v[66:67], v[10:11] op_sel_hi:[1,0] neg_lo:[0,1] neg_hi:[0,1]
    v_pk_fma_f32 v[12:13], v[64:65], v[64:65], v[12:13]
    v_pk_add_f32 v[68:69], v[68:69], v[10:11] op_sel_hi:[1,0] neg_lo:[0,1] neg_hi:[0,1]
    v_pk_fma_f32 v[14:15], v[66:67], v[66:67], v[14:15]
    v_pk_add_f32 v[70:71], v[70:71], v[10:11] op_sel_hi:[1,0] neg_lo:[0,1] neg_hi:[0,1]
    v_pk_fma_f32 v[12:13], v[68:69], v[68:69], v[12:13]
    v_pk_add_f32 v[72:73], v[72:73], v[10:11] op_sel_hi:[1,0] neg_lo:[0,1] neg_hi:[0,1]
    v_pk_fma_f32 v[14:15], v[70:71], v[70:71], v[14:15]
    v_pk_add_f32 v[74:75], v[74:75], v[10:11] op_sel_hi:[1,0] neg_lo:[0,1] neg_hi:[0,1]
    v_pk_fma_f32 v[12:13], v[72:73], v[72:73], v[12:13]
    v_pk_add_f32 v[76:77], v[76:77], v[10:11] op_sel_hi:[1,0] neg_lo:[0,1] neg_hi:[0,1]
    v_pk_fma_f32 v[14:15], v[74:75], v[74:75], v[14:15]
    v_pk_add_f32 v[78:79], v[78:79], v[10:11] op_sel_hi:[1,0] neg_lo:[0,1] neg_hi:[0,1]
    v_pk_fma_f32 v[12:13], v[76:77], v[76:77], v[12:13]
    v_pk_add_f32 v[80:81], v[80:81], v[10:11] op_sel_hi:[1,0] neg_lo:[0,1] neg_hi:[0,1]
    v_pk_fma_f32 v[14:15], v[78:79], v[78:79], v[14:15]
    v_pk_add_f32 v[82:83], v[82:83], v[10:11] op_sel_hi:[1,0] neg_lo:[0,1] neg_hi:[0,1]
    v_pk_fma_f32 v[12:13], v[80:81], v[80:81], v[12:13]
    v_pk_add_f32 v[84:85], v[84:85], v[10:11] op_sel_hi:[1,0] neg_lo:[0,1] neg_hi:[0,1]
    v_pk_fma_f32 v[14:15], v[82:83], v[82:83], v[14:15]
    v_pk_add_f32 v[86:87], v[86:87], v[10:11] op_sel_hi:[1,0] neg_lo:[0,1] neg_hi:[0,1]
    v_pk_fma_f32 v[12:13], v[84:85], v[84:85], v[12:13]
    v_pk_add_f32 v[88:89], v[88:89], v[10:11] op_sel_hi:[1,0] neg_lo:[0,1] neg_hi:[0,1]
    v_pk_fma_f32 v[14:15], v[86:87], v[86:87], v[14:15]
    v_pk_add_f32 v[90:91], v[90:91], v[10:11] op_sel_hi:[1,0] neg_lo:[0,1] neg_hi:[0,1]
    v_pk_fma_f32 v[12:13], v[88:89], v[88:89], v[12:13]
    v_pk_add_f32 v[92:93], v[92:93], v[10:11] op_sel_hi:[1,0] neg_lo:[0,1] neg_hi:[0,1]
    v_pk_fma_f32 v[14:15], v[90:91], v[90:91], v[14:15]
    v_pk_add_f32 v[94:95], v[94:95], v[10:11] op_sel_hi:[1,0] neg_lo:[0,1] neg_hi:[0,1]
    v_pk_fma_f32 v[12:13], v[92:93], v[92:93], v[12:13]
    v_pk_add_f32 v[96:97], v[96:97], v[10:11] op_sel_hi:[1,0] neg_lo:[0,1] neg_hi:[0,1]
    v_pk_fma_f32 v[14:15], v[94:95], v[94:95], v[14:15]
    v_pk_add_f32 v[98:99], v[98:99], v[10:11] op_sel_hi:[1,0] neg_lo:[0,1] neg_hi:[0,1]
    v_pk_fma_f32 v[12:13], v[96:97], v[96:97], v[12:13]
    v_pk_add_f32 v[100:101], v[100:101], v[10:11] op_sel_hi:[1,0] neg_lo:[0,1] neg_hi:[0,1]
    v_pk_fma_f32 v[14:15], v[98:99], v[98:99], v[14:15]
    v_pk_add_f32 v[102:103], v[102:103], v[10:11] op_sel_hi:[1,0] neg_lo:[0,1] neg_hi:[0,1]
    v_pk_fma_f32 v[12:13], v[100:101], v[100:101], v[12:13]
    v_pk_add_f32 v[104:105], v[104:105], v[10:11] op_sel_hi:[1,0] neg_lo:[0,1] neg_hi:[0,1]
    v_pk_fma_f32 v[14:15], v[102:103], v[102:103], v[14:15]
    v_pk_add_f32 v[106:107], v[106:107], v[10:11] op_sel_hi:[1,0] neg_lo:[0,1] neg_hi:[0,1]
    v_pk_fma_f32 v[12:13], v[104:105], v[104:105], v[12:13]
    v_pk_add_f32 v[108:109], v[108:109], v[10:11] op_sel_hi:[1,0] neg_lo:[0,1] neg_hi:[0,1]
    v_pk_fma_f32 v[14:15], v[106:107], v[106:107], v[14:15]
    v_pk_add_f32 v[110:111], v[110:111], v[10:11] op_sel_hi:[1,0] neg_lo:[0,1] neg_hi:[0,1]
    v_pk_fma_f32 v[12:13], v[108:109], v[108:109], v[12:13]
    v_pk_fma_f32 v[14:15], v[110:111], v[110:111], v[14:15]
    v_pk_add_f32 v[12:13], v[12:13], v[14:15]
    v_add_f32 v11, v12, v13
    ds_write_b64 v9, v[10:11]
    s_mov_b64 exec, 1
    ds_add_u32 v242, v243
    s_mov_b64 exec, -1
    s_waitcnt vmcnt(0)
    ds_read_b64_tr_b16 v[144:145], v6 offset:34816
    ds_read_b64_tr_b16 v[146:147], v6 offset:34944
    ds_read_b64_tr_b16 v[148:149], v6 offset:35328
    ds_read_b64_tr_b16 v[150:151], v6 offset:35456
    ds_read_b64_tr_b16 v[152:153], v6 offset:35840
    ds_read_b64_tr_b16 v[154:155], v6 offset:35968
    ds_read_b64_tr_b16 v[156:157], v6 offset:36352
    ds_read_b64_tr_b16 v[158:159], v6 offset:36480
fk_lw_1:
    ds_read_b32 v244, v242
    s_waitcnt lgkmcnt(0)
    v_readfirstlane_b32 s98, v244
    s_cmp_ge_u32 s98, 4
    s_cbranch_scc1 fk_lwk_2
    s_branch fk_lw_1
fk_lwk_2:
    ds_read_b128 v[112:115], v8 offset:0
    ds_read_b128 v[116:119], v8 offset:16
    ds_read_b128 v[120:123], v8 offset:32
    ds_read_b128 v[124:127], v8 offset:48
    ds_read_b64_tr_b16 v[160:161], v6 offset:36864
    ds_read_b64_tr_b16 v[162:163], v6 offset:36992
    ds_read_b64_tr_b16 v[164:165], v6 offset:37376
    ds_read_b64_tr_b16 v[166:167], v6 offset:37504
    ds_read_b64_tr_b16 v[168:169], v6 offset:37888
    ds_read_b64_tr_b16 v[170:171], v6 offset:38016
    ds_read_b64_tr_b16 v[172:173], v6 offset:38400
    ds_read_b64_tr_b16 v[174:175], v6 offset:38528
    s_mul_i32 s61, s61, 0x9e3779b1
    s_add_u32 s61, s61, 0x7f4a7c15
    s_waitcnt lgkmcnt(8)
    v_pk_add_f32 v[12:13], v[112:113], v[114:115]
    v_pk_add_f32 v[14:15], v[116:117], v[118:119]
    v_pk_add_f32 v[128:129], v[120:121], v[122:123]
    v_pk_add_f32 v[130:131], v[124:125], v[126:127]
    v_pk_add_f32 v[12:13], v[12:13], v[14:15]
    v_pk_add_f32 v[128:129], v[128:129], v[130:131]
    v_pk_add_f32 v[12:13], v[12:13], v[128:129]
    v_mul_f32 v12, 0x3e000000, v12
    v_sub_f32 v112, v112, v12
    v_sub_f32 v114, v114, v12
    v_sub_f32 v116, v116, v12
    v_sub_f32 v118, v118, v12
    v_sub_f32 v120, v120, v12
    v_sub_f32 v122, v122, v12
    v_sub_f32 v124, v124, v12
    v_sub_f32 v126, v126, v12
    v_mul_f32 v14, v112, v112
    v_mul_f32 v15, v114, v114
    v_fmac_f32 v14, v116, v116
    v_fmac_f32 v15, v118, v118
    v_fmac_f32 v14, v120, v120
    v_fmac_f32 v15, v122, v122
    v_fmac_f32 v14, v124, v124
    v_fmac_f32 v15, v126, v126
    v_add_f32 v14, v14, v15
    v_mov_b32 v15, 0x42800000
    v_fmac_f32 v13, v14, v15
    v_mul_f32 v13, 0x3b000000, v13
    v_cvt_pk_bf16_f32 v12, v12, v12
    v_lshlrev_b32 v12, 16, v12
    v_cvt_pk_bf16_f32 v13, v13, v13
    v_lshlrev_b32 v13, 16, v13
    v_add_f32 v13, 0x3727c5ac, v13
    v_cvt_pk_bf16_f32 v13, v13, v13
    v_lshlrev_b32 v13, 16, v13
    v_sqrt_f32 v13, v13
    v_sub_f32 v10, v10, v12
    v_cvt_pk_bf16_f32 v13, v13, v13
    v_lshlrev_b32 v13, 16, v13
    v_rcp_f32 v12, v13
    s_waitcnt lgkmcnt(0)
    v_mul_f32 v14, v10, v12
    v_pk_fma_f32 v[48:49], v[48:49], v[12:13], v[14:15] op_sel_hi:[1,0,0]
    v_pk_fma_f32 v[50:51], v[50:51], v[12:13], v[14:15] op_sel_hi:[1,0,0]
    v_pk_fma_f32 v[52:53], v[52:53], v[12:13], v[14:15] op_sel_hi:[1,0,0]
    v_pk_fma_f32 v[54:55], v[54:55], v[12:13], v[14:15] op_sel_hi:[1,0,0]
    v_cvt_pk_bf16_f32 v16, v48, v49
    v_cvt_pk_bf16_f32 v17, v50, v51
    v_cvt_pk_bf16_f32 v18, v52, v53
    v_cvt_pk_bf16_f32 v19, v54, v55
    v_pk_fma_f32 v[56:57], v[56:57], v[12:13], v[14:15] op_sel_hi:[1,0,0]
    v_pk_fma_f32 v[58:59], v[58:59], v[12:13], v[14:15] op_sel_hi:[1,0,0]
    v_pk_fma_f32 v[60:61], v[60:61], v[12:13], v[14:15] op_sel_hi:[1,0,0]
    v_pk_fma_f32 v[62:63], v[62:63], v[12:13], v[14:15] op_sel_hi:[1,0,0]
    v_cvt_pk_bf16_f32 v20, v56, v57
    v_cvt_pk_bf16_f32 v21, v58, v59
    v_cvt_pk_bf16_f32 v22, v60, v61
    v_cvt_pk_bf16_f32 v23, v62, v63
    v_pk_fma_f32 v[64:65], v[64:65], v[12:13], v[14:15] op_sel_hi:[1,0,0]
    v_pk_fma_f32 v[66:67], v[66:67], v[12:13], v[14:15] op_sel_hi:[1,0,0]
    v_pk_fma_f32 v[68:69], v[68:69], v[12:13], v[14:15] op_sel_hi:[1,0,0]
    v_pk_fma_f32 v[70:71], v[70:71], v[12:13], v[14:15] op_sel_hi:[1,0,0]
    v_cvt_pk_bf16_f32 v24, v64, v65
    v_cvt_pk_bf16_f32 v25, v66, v67
    v_cvt_pk_bf16_f32 v26, v68, v69
    v_cvt_pk_bf16_f32 v27, v70, v71
    v_pk_fma_f32 v[72:73], v[72:73], v[12:13], v[14:15] op_sel_hi:[1,0,0]
    v_pk_fma_f32 v[74:75], v[74:75], v[12:13], v[14:15] op_sel_hi:[1,0,0]
    v_pk_fma_f32 v[76:77], v[76:77], v[12:13], v[14:15] op_sel_hi:[1,0,0]
    v_pk_fma_f32 v[78:79], v[78:79], v[12:13], v[14:15] op_sel_hi:[1,0,0]
    v_cvt_pk_bf16_f32 v28, v72, v73
    v_cvt_pk_bf16_f32 v29, v74, v75
    v_cvt_pk_bf16_f32 v30, v76, v77
    v_cvt_pk_bf16_f32 v31, v78, v79
    v_pk_fma_f32 v[80:81], v[80:81], v[12:13], v[14:15] op_sel_hi:[1,0,0]
    v_pk_fma_f32 v[82:83], v[82:83], v[12:13], v[14:15] op_sel_hi:[1,0,0]
    v_pk_fma_f32 v[84:85], v[84:85], v[12:13], v[14:15] op_sel_hi:[1,0,0]
    v_pk_fma_f32 v[86:87], v[86:87], v[12:13], v[14:15] op_sel_hi:[1,0,0]
    v_cvt_pk_bf16_f32 v32, v80, v81
    v_cvt_pk_bf16_f32 v33, v82, v83
    v_cvt_pk_bf16_f32 v34, v84, v85
    v_cvt_pk_bf16_f32 v35, v86, v87
    v_pk_fma_f32 v[88:89], v[88:89], v[12:13], v[14:15] op_sel_hi:[1,0,0]
    v_pk_fma_f32 v[90:91], v[90:91], v[12:13], v[14:15] op_sel_hi:[1,0,0]
    v_pk_fma_f32 v[92:93], v[92:93], v[12:13], v[14:15] op_sel_hi:[1,0,0]
    v_pk_fma_f32 v[94:95], v[94:95], v[12:13], v[14:15] op_sel_hi:[1,0,0]
    v_cvt_pk_bf16_f32 v36, v88, v89
    v_cvt_pk_bf16_f32 v37, v90, v91
    v_cvt_pk_bf16_f32 v38, v92, v93
    v_cvt_pk_bf16_f32 v39, v94, v95
    v_pk_fma_f32 v[96:97], v[96:97], v[12:13], v[14:15] op_sel_hi:[1,0,0]
    v_pk_fma_f32 v[98:99], v[98:99], v[12:13], v[14:15] op_sel_hi:[1,0,0]
    v_pk_fma_f32 v[100:101], v[100:101], v[12:13], v[14:15] op_sel_hi:[1,0,0]
    v_pk_fma_f32 v[102:103], v[102:103], v[12:13], v[14:15] op_sel_hi:[1,0,0]
    v_cvt_pk_bf16_f32 v40, v96, v97
    v_cvt_pk_bf16_f32 v41, v98, v99
    v_cvt_pk_bf16_f32 v42, v100, v101
    v_cvt_pk_bf16_f32 v43, v102, v103
    v_pk_fma_f32 v[104:105], v[104:105], v[12:13], v[14:15] op_sel_hi:[1,0,0]
    v_pk_fma_f32 v[106:107], v[106:107], v[12:13], v[14:15] op_sel_hi:[1,0,0]
    v_pk_fma_f32 v[108:109], v[108:109], v[12:13], v[14:15] op_sel_hi:[1,0,0]
    v_pk_fma_f32 v[110:111], v[110:111], v[12:13], v[14:15] op_sel_hi:[1,0,0]
    v_cvt_pk_bf16_f32 v44, v104, v105
    v_cvt_pk_bf16_f32 v45, v106, v107
    v_cvt_pk_bf16_f32 v46, v108, v109
    v_cvt_pk_bf16_f32 v47, v110, v111
    s_cmp_eq_u32 s58, 1
    s_cbranch_scc1 fk_f_nv
    v_mfma_f32_32x32x16_bf16 v[128:143], v[144:147], v[16:19], 0
    ds_write_b128 v7, v[16:19] offset:0
    v_mfma_f32_32x32x16_bf16 v[128:143], v[148:151], v[20:23], v[128:143]
    ds_write_b128 v7, v[20:23] offset:1024
    v_mfma_f32_32x32x16_bf16 v[128:143], v[152:155], v[24:27], v[128:143]
    ds_write_b128 v7, v[24:27] offset:2048
    v_mfma_f32_32x32x16_bf16 v[128:143], v[156:159], v[28:31], v[128:143]
    ds_write_b128 v7, v[28:31] offset:3072
    v_mfma_f32_32x32x16_bf16 v[128:143], v[160:163], v[32:35], v[128:143]
    v_mfma_f32_32x32x16_bf16 v[128:143], v[164:167], v[36:39], v[128:143]
    v_mfma_f32_32x32x16_bf16 v[128:143], v[168:171], v[40:43], v[128:143]
    v_mfma_f32_32x32x16_bf16 v[128:143], v[172:175], v[44:47], v[128:143]
    v_add_u32 v6, s62, v255
    v_and_b32 v2, 16, v254
    v_cmp_ne_u32 vcc, 0, v2
    s_nop 8
    s_branch fk_f_np
fk_f_nv:
    v_mfma_f32_32x32x16_bf16 v[128:143], v[16:19], v[144:147], 0
    ds_write_b128 v7, v[16:19] offset:0
    v_mfma_f32_32x32x16_bf16 v[128:143], v[20:23], v[148:151], v[128:143]
    ds_write_b128 v7, v[20:23] offset:1024
    v_mfma_f32_32x32x16_bf16 v[128:143], v[24:27], v[152:155], v[128:143]
    ds_write_b128 v7, v[24:27] offset:2048
    v_mfma_f32_32x32x16_bf16 v[128:143], v[28:31], v[156:159], v[128:143]
    ds_write_b128 v7, v[28:31] offset:3072
    v_mfma_f32_32x32x16_bf16 v[128:143], v[32:35], v[160:163], v[128:143]
    v_mfma_f32_32x32x16_bf16 v[128:143], v[36:39], v[164:167], v[128:143]
    v_mfma_f32_32x32x16_bf16 v[128:143], v[40:43], v[168:171], v[128:143]
    v_mfma_f32_32x32x16_bf16 v[128:143], v[44:47], v[172:175], v[128:143]
    v_add_u32 v6, s62, v255
    v_and_b32 v2, 16, v254
    v_cmp_ne_u32 vcc, 0, v2
    s_nop 8
    v_cndmask_b32 v128, v128, v136, vcc
    v_cndmask_b32 v129, v129, v137, vcc
    v_cndmask_b32 v130, v130, v138, vcc
    v_cndmask_b32 v131, v131, v139, vcc
    v_cndmask_b32 v132, v132, v140, vcc
    v_cndmask_b32 v133, v133, v141, vcc
    v_cndmask_b32 v134, v134, v142, vcc
    v_cndmask_b32 v135, v135, v143, vcc
fk_f_np:
    ds_write_b128 v6, v[128:131] offset:34816
    ds_write_b128 v6, v[132:135] offset:35840
    s_mov_b64 exec, 1
    ds_add_u32 v242, v243 offset:16
    s_mov_b64 exec, -1
    ds_write_b128 v7, v[32:35] offset:4096
    ds_write_b128 v7, v[36:39] offset:5120
    ds_write_b128 v7, v[40:43] offset:6144
    ds_write_b128 v7, v[44:47] offset:7168
    v_mov_b32 v2, s61
    ds_write_b32 v242, v2 offset:12
    s_mov_b64 exec, 1
    ds_add_u32 v242, v243
    s_mov_b64 exec, -1
    s_cmp_eq_u32 s92, s58
    s_cbranch_scc1 fk_f_xn
    s_add_u32 s62, s92, s58
    s_cmp_lg_u32 s62, 3
    s_cbranch_scc1 fk_f_common
    s_cmp_ge_u32 s58, 2
    s_cbranch_scc1 fk_f_gate
    s_lshl_b32 s63, s57, 1
    s_add_u32 s63, s63, s58
    s_lshl_b32 s62, s63, 10
    s_add_u32 s62, s62, 65536
    s_lshl_b32 s63, s63, 6
    s_add_u32 s63, s63, 8192
    v_lshrrev_b32 v87, 1, v255
    v_xor_b32 v87, v87, v255
    v_and_b32 v87, 64, v87
    v_mul_u32_u24 v87, 3, v87
    s_cmp_eq_u32 s58, 0
    s_cselect_b32 s98, -1, 0
    v_and_b32 v87, s98, v87
    v_xor_b32 v86, v87, v255
    v_mov_b32 v2, 159760
fk_lw_3:
    ds_read_b32 v244, v2
    s_waitcnt lgkmcnt(0)
    v_readfirstlane_b32 s98, v244
    s_cmp_ge_u32 s98, 4
    s_cbranch_scc1 fk_lwk_4
    s_branch fk_lw_3
fk_lwk_4:
    ds_read_b128 v[48:51], v255 offset:34816
    ds_read_b128 v[52:55], v255 offset:35840
    ds_read_b128 v[56:59], v255 offset:38912
    ds_read_b128 v[60:63], v255 offset:39936
    ds_read_b128 v[64:67], v255 offset:43008
    ds_read_b128 v[68:71], v255 offset:44032
    ds_read_b128 v[72:75], v255 offset:47104
    ds_read_b128 v[76:79], v255 offset:48128
    s_waitcnt lgkmcnt(0)
    v_pk_add_f32 v[48:49], v[48:49], v[56:57]
    v_pk_add_f32 v[64:65], v[64:65], v[72:73]
    v_pk_add_f32 v[50:51], v[50:51], v[58:59]
    v_pk_add_f32 v[66:67], v[66:67], v[74:75]
    v_pk_add_f32 v[52:53], v[52:53], v[60:61]
    v_pk_add_f32 v[68:69], v[68:69], v[76:77]
    v_pk_add_f32 v[54:55], v[54:55], v[62:63]
    v_pk_add_f32 v[70:71], v[70:71], v[78:79]
    v_pk_add_f32 v[48:49], v[48:49], v[64:65]
    v_pk_add_f32 v[50:51], v[50:51], v[66:67]
    v_pk_add_f32 v[52:53], v[52:53], v[68:69]
    v_pk_add_f32 v[54:55], v[54:55], v[70:71]
    v_cvt_pk_bf16_f32 v80, v48, v49
    v_cvt_pk_bf16_f32 v81, v50, v51
    v_cvt_pk_bf16_f32 v82, v52, v53
    v_cvt_pk_bf16_f32 v83, v54, v55
    buffer_store_dwordx4 v[80:83], v86, s[28:31], s62 offen sc1
    v_mov_b32 v84, 0
    v_mov_b32 v85, s61
    s_waitcnt vmcnt(0)
    s_mov_b64 exec, 1
    buffer_store_dword v85, v84, s[28:31], s63 offen sc1
    s_mov_b64 exec, -1
    s_branch fk_f_gate
fk_f_xn:
    s_lshl_b32 s62, s57, 2
    s_add_u32 s62, s62, s58
    s_lshl_b32 s62, s62, 13
    s_add_u32 s62, s62, 1048576
    s_add_u32 s63, s62, 4096
    buffer_store_dwordx4 v[16:19], v255, s[28:31], s62 offen offset:0 sc1
    buffer_store_dwordx4 v[20:23], v255, s[28:31], s62 offen offset:1024 sc1
    buffer_store_dwordx4 v[24:27], v255, s[28:31], s62 offen offset:2048 sc1
    buffer_store_dwordx4 v[28:31], v255, s[28:31], s62 offen offset:3072 sc1
    buffer_store_dwordx4 v[32:35], v255, s[28:31], s63 offen offset:0 sc1
    buffer_store_dwordx4 v[36:39], v255, s[28:31], s63 offen offset:1024 sc1
    buffer_store_dwordx4 v[40:43], v255, s[28:31], s63 offen offset:2048 sc1
    buffer_store_dwordx4 v[44:47], v255, s[28:31], s63 offen offset:3072 sc1
    s_lshl_b32 s63, s57, 13
    s_lshl_b32 s62, s58, 6
    s_add_u32 s63, s63, s62
    s_add_u32 s63, s63, 266240
    v_mov_b32 v84, 0
    v_mov_b32 v85, s61
    s_waitcnt vmcnt(0)
    s_mov_b64 exec, 1
    buffer_store_dword v85, v84, s[28:31], s63 offen sc1
    s_mov_b64 exec, -1
fk_f_gate:
    s_mov_b64 exec, 1
    ds_add_u32 v242, v243 offset:8
    s_mov_b64 exec, -1
fk_f_common:
    s_cmp_lt_u32 s92, 2
    s_cselect_b32 s40, s16, s18
    s_cselect_b32 s41, s17, s19
    s_mov_b32 s42, 1409024
    s_mov_b32 s43, 0x00020000
    s_mov_b32 s44, s20
    s_mov_b32 s45, s21
    s_mov_b32 s46, 0x158000
    s_mov_b32 s47, 0x00020000
    s_mov_b32 s48, s12
    s_mov_b32 s49, s13
    s_mov_b32 s50, 0x80000
    s_mov_b32 s51, 0x00020000
    s_mov_b32 s52, s22
    s_mov_b32 s53, s23
    s_mov_b32 s54, 0x200000
    s_mov_b32 s55, 0x00020000
    s_and_b32 s93, s59, 1
    s_lshl_b32 s93, s93, 3
    s_and_b32 s62, s60, 7
    s_add_u32 s93, s93, s62
    s_lshl_b32 s93, s93, 2
    s_add_u32 s93, s93, s92
    s_lshr_b32 s101, s59, 1
    s_lshl_b32 s101, s101, 2
    s_add_u32 s101, s101, s58
    s_xor_b32 s101, s101, 2
    s_lshl_b32 s62, 1, s101
    s_sub_u32 s62, s62, 1
    s_and_b32 s62, s62, 8499
    s_bcnt1_i32_b32 s62, s62
    s_mul_i32 s94, s101, 5
    s_add_u32 s94, s94, s62
    s_lshr_b32 s22, 8499, s101
    s_and_b32 s22, s22, 1
    s_lshl_b32 s3, s22, 1
    s_add_u32 s3, s3, 10
    v_mov_b32 v228, 0x40000000
    s_lshl_b32 s95, s94, 5
    s_lshl_b32 s96, s93, 15
    s_add_u32 s96, s96, 1048576
    s_lshr_b32 s62, s92, 1
    s_mul_i32 s97, s62, 6176
    s_and_b32 s62, s92, 1
    s_mul_i32 s63, s62, 3072
    s_add_u32 s97, s97, s63
    s_add_u32 s97, s97, 73728
    s_mul_i32 s62, s62, 192
    v_add_u32 v239, s62, v254
    v_mul_u32_u24 v240, 43691, v239
    v_lshrrev_b32 v240, 19, v240
    v_mul_u32_u24 v241, 12, v240
    v_sub_u32 v241, v239, v241
    v_mul_u32_u24 v234, 2752, v240
    v_cmp_le_u32 vcc, s3, v241
    v_lshl_add_u32 v234, v241, 4, v234
    s_nop 0
    v_cndmask_b32 v234, v234, v228, vcc
    v_add_u32 v239, s62, v254
    v_add_u32 v239, 64, v239
    v_mul_u32_u24 v240, 43691, v239
    v_lshrrev_b32 v240, 19, v240
    v_mul_u32_u24 v241, 12, v240
    v_sub_u32 v241, v239, v241
    v_mul_u32_u24 v235, 2752, v240
    v_cmp_le_u32 vcc, s3, v241
    v_lshl_add_u32 v235, v241, 4, v235
    s_nop 0
    v_cndmask_b32 v235, v235, v228, vcc
    v_add_u32 v239, s62, v254
    v_add_u32 v239, 128, v239
    v_mul_u32_u24 v240, 43691, v239
    v_lshrrev_b32 v240, 19, v240
    v_mul_u32_u24 v241, 12, v240
    v_sub_u32 v241, v239, v241
    v_mul_u32_u24 v236, 2752, v240
    v_cmp_le_u32 vcc, s3, v241
    v_lshl_add_u32 v236, v241, 4, v236
    s_nop 0
    v_cndmask_b32 v236, v236, v228, vcc
    v_bfe_u32 v239, v254, 4, 1
    v_mul_u32_u24 v237, 6176, v239
    v_lshrrev_b32 v239, 5, v254
    v_bfe_u32 v240, v254, 2, 2
    v_lshl_add_u32 v239, v239, 3, v240
    v_mul_u32_u24 v239, 192, v239
    v_add_u32 v237, v237, v239
    v_and_b32 v240, 3, v254
    v_lshl_add_u32 v237, v240, 3, v237
    v_add_u32 v237, 73728, v237
    v_add_u32 v238, 36960, v237
    v_mov_b32 v246, 0xc0135761
    v_mov_b32 v247, 0xc0135761
    v_mov_b32 v248, 0xbdd2d3e8
    v_mov_b32 v249, 0xbdd2d3e8
    v_mov_b32 v250, 0x3f800000
    v_mov_b32 v251, 0x3f800000
    v_lshrrev_b32 v239, 5, v254
    v_bfe_u32 v240, v254, 2, 2
    v_lshl_add_u32 v239, v239, 2, v240
    v_lshlrev_b32 v224, 7, v239
    v_and_b32 v239, 1, v254
    v_lshl_add_u32 v224, v239, 5, v224
    v_bfe_u32 v239, v254, 4, 1
    v_lshl_add_u32 v224, v239, 4, v224
    v_bfe_u32 v239, v254, 1, 1
    v_lshl_add_u32 v224, v239, 3, v224
    s_mul_i32 s62, s92, 18432
    s_add_u32 s62, s62, 73728
    v_add_u32 v224, s62, v224
    v_bfe_u32 v239, v254, 3, 1
    s_lshr_b32 s62, s92, 1
    v_xor_b32 v239, s62, v239
    v_xor_b32 v240, 1, v239
    v_lshl_add_u32 v225, v240, 6, v224
    v_lshl_add_u32 v224, v239, 6, v224
    v_lshrrev_b32 v239, 3, v254
    v_and_b32 v240, 7, v254
    v_bfe_u32 v241, v254, 4, 1
    v_lshlrev_b32 v241, 2, v241
    v_xor_b32 v240, v240, v241
    v_lshlrev_b32 v226, 10, v239
    v_lshl_add_u32 v226, v240, 4, v226
    v_lshrrev_b32 v239, 2, v254
    v_lshlrev_b32 v227, 13, v239
    v_and_b32 v240, 3, v254
    v_lshl_add_u32 v227, v240, 6, v227
    v_lshlrev_b32 v233, 6, v254
    v_mov_b32 v241, 159748
    v_mov_b32 v232, s61
    v_lshlrev_b32 v231, 7, v254
    v_lshlrev_b32 v240, 20, v254
    v_mov_b32 v239, 159752
fk_lw_5:
    ds_read_b32 v244, v239
    s_waitcnt lgkmcnt(0)
    v_readfirstlane_b32 s98, v244
    s_cmp_ge_u32 s98, 2
    s_cbranch_scc1 fk_lwk_6
    s_sleep 1
    s_branch fk_lw_5
fk_lwk_6:
    s_add_u32 s62, s95, 0
    buffer_load_dwordx4 v[0:3], v234, s[40:43], s62 offen
    buffer_load_dwordx4 v[4:7], v235, s[40:43], s62 offen
    buffer_load_dwordx4 v[8:11], v236, s[40:43], s62 offen
    s_add_u32 s62, s95, 88064
    buffer_load_dwordx4 v[12:15], v234, s[40:43], s62 offen
    buffer_load_dwordx4 v[16:19], v235, s[40:43], s62 offen
    buffer_load_dwordx4 v[20:23], v236, s[40:43], s62 offen
    s_add_u32 s62, s95, 176128
    buffer_load_dwordx4 v[24:27], v234, s[40:43], s62 offen
    buffer_load_dwordx4 v[28:31], v235, s[40:43], s62 offen
    buffer_load_dwordx4 v[32:35], v236, s[40:43], s62 offen
    s_add_u32 s62, s95, 264192
    buffer_load_dwordx4 v[36:39], v234, s[40:43], s62 offen
    buffer_load_dwordx4 v[40:43], v235, s[40:43], s62 offen
    buffer_load_dwordx4 v[44:47], v236, s[40:43], s62 offen
    s_add_u32 s62, s95, 352256
    buffer_load_dwordx4 v[48:51], v234, s[40:43], s62 offen
    buffer_load_dwordx4 v[52:55], v235, s[40:43], s62 offen
    buffer_load_dwordx4 v[56:59], v236, s[40:43], s62 offen
    s_lshl_b32 s62, s93, 13
    s_add_u32 s62, s62, 266240
    v_lshlrev_b32 v239, 6, v254
    s_mov_b32 s3, 0
fk_poll_7:
    s_mov_b64 exec, 0xf
    buffer_load_dword v244, v239, s[28:31], s62 offen sc1
    s_waitcnt vmcnt(0)
    v_cmp_eq_u32 vcc, s61, v244
    s_mov_b64 exec, -1
    s_cmp_eq_u64 vcc, 0xf
    s_cbranch_scc1 fk_pollok_8
    s_sleep 4
    s_add_u32 s3, s3, 1
    s_cmp_lt_u32 s3, 32768
    s_cbranch_scc1 fk_poll_7
fk_pollok_8:
    s_add_u32 s63, s96, 0
    buffer_load_dwordx4 v[96:99], v255, s[28:31], s63 offen sc1
    s_add_u32 s63, s96, 1024
    buffer_load_dwordx4 v[100:103], v255, s[28:31], s63 offen sc1
    s_add_u32 s63, s96, 2048
    buffer_load_dwordx4 v[104:107], v255, s[28:31], s63 offen sc1
    s_add_u32 s63, s96, 3072
    buffer_load_dwordx4 v[108:111], v255, s[28:31], s63 offen sc1
    s_add_u32 s63, s96, 4096
    buffer_load_dwordx4 v[112:115], v255, s[28:31], s63 offen sc1
    s_add_u32 s63, s96, 5120
    buffer_load_dwordx4 v[116:119], v255, s[28:31], s63 offen sc1
    s_add_u32 s63, s96, 6144
    buffer_load_dwordx4 v[120:123], v255, s[28:31], s63 offen sc1
    v_add_u32 v239, s97, v255
fk_lw_9:
    ds_read_b32 v244, v241
    s_waitcnt lgkmcnt(0)
    v_readfirstlane_b32 s98, v244
    s_cmp_ge_u32 s98, 16
    s_cbranch_scc1 fk_lwk_10
    s_sleep 1
    s_branch fk_lw_9
fk_lwk_10:
    ds_write_b128 v239, v[0:3] offset:0
    ds_write_b128 v239, v[4:7] offset:1024
    ds_write_b128 v239, v[8:11] offset:2048
    ds_write_b128 v239, v[12:15] offset:12320
    ds_write_b128 v239, v[16:19] offset:13344
    ds_write_b128 v239, v[20:23] offset:14368
    s_waitcnt lgkmcnt(3)
    s_mov_b64 exec, 1
    ds_add_u32 v242, v243
    s_mov_b64 exec, -1
    ds_write_b128 v239, v[24:27] offset:24640
    ds_write_b128 v239, v[28:31] offset:25664
    ds_write_b128 v239, v[32:35] offset:26688
    ds_write_b128 v239, v[36:39] offset:36960
    ds_write_b128 v239, v[40:43] offset:37984
    ds_write_b128 v239, v[44:47] offset:39008
    s_waitcnt lgkmcnt(7)
    ds_write_b128 v239, v[48:51] offset:49280
    ds_write_b128 v239, v[52:55] offset:50304
    ds_write_b128 v239, v[56:59] offset:51328
    ds_read_b32 v244, v242
    s_setprio 2
    s_waitcnt lgkmcnt(0)
fk_sbr_11:
    v_readfirstlane_b32 s98, v244
    s_cmp_ge_u32 s98, 12
    s_cbranch_scc1 fk_sbk_12
    ds_read_b32 v244, v242
    s_waitcnt lgkmcnt(0)
    s_branch fk_sbr_11
fk_sbk_12:
    s_setprio 0
    ds_read_b64_tr_b16 v[128:129], v237 offset:0
    ds_read_b64_tr_b16 v[130:131], v237 offset:768
    ds_read_b64_tr_b16 v[132:133], v237 offset:32
    ds_read_b64_tr_b16 v[134:135], v237 offset:800
    ds_read_b64_tr_b16 v[136:137], v237 offset:64
    ds_read_b64_tr_b16 v[138:139], v237 offset:832
    ds_read_b64_tr_b16 v[140:141], v237 offset:96
    ds_read_b64_tr_b16 v[142:143], v237 offset:864
    ds_read_b64_tr_b16 v[144:145], v237 offset:128
    ds_read_b64_tr_b16 v[146:147], v237 offset:896
    ds_read_b64_tr_b16 v[148:149], v237 offset:160
    ds_read_b64_tr_b16 v[150:151], v237 offset:928
    s_mov_b64 exec, 1
    ds_add_u32 v242, v243
    s_mov_b64 exec, -1
    s_mov_b32 vcc_lo, s22
    s_mov_b32 vcc_hi, 0
    s_waitcnt vmcnt(6)
    s_waitcnt lgkmcnt(7)
    v_mfma_f32_32x32x16_bf16 v[0:15], v[128:131], v[96:99], 0
    v_mfma_f32_32x32x16_bf16 v[16:31], v[132:135], v[96:99], 0
    v_mfma_f32_32x32x16_bf16 v[32:47], v[136:139], v[96:99], 0
    ds_read_b64_tr_b16 v[152:153], v237 offset:3072
    ds_read_b64_tr_b16 v[154:155], v237 offset:3840
    s_add_u32 s63, s96, 7168
    buffer_load_dwordx4 v[124:127], v255, s[28:31], s63 offen sc1
    ds_read_b64_tr_b16 v[156:157], v237 offset:3104
    ds_read_b64_tr_b16 v[158:159], v237 offset:3872
    ds_read_b64_tr_b16 v[160:161], v237 offset:3136
    ds_read_b64_tr_b16 v[162:163], v237 offset:3904
    s_waitcnt lgkmcnt(7)
    v_mfma_f32_32x32x16_bf16 v[48:63], v[140:143], v[96:99], 0
    v_mfma_f32_32x32x16_bf16 v[64:79], v[144:147], v[96:99], 0
    s_cbranch_vccz fk_no6_0
    v_mfma_f32_32x32x16_bf16 v[80:95], v[148:151], v[96:99], 0
fk_no6_0:
    ds_read_b64_tr_b16 v[164:165], v237 offset:3168
    ds_read_b64_tr_b16 v[166:167], v237 offset:3936
    ds_read_b32 v244, v242
    ds_read_b64_tr_b16 v[168:169], v237 offset:3200
    ds_read_b64_tr_b16 v[170:171], v237 offset:3968
    ds_read_b64_tr_b16 v[172:173], v237 offset:3232
    ds_read_b64_tr_b16 v[174:175], v237 offset:4000
    s_waitcnt vmcnt(6)
    s_waitcnt lgkmcnt(7)
    v_mfma_f32_32x32x16_bf16 v[0:15], v[152:155], v[100:103], v[0:15]
    v_mfma_f32_32x32x16_bf16 v[16:31], v[156:159], v[100:103], v[16:31]
    v_mfma_f32_32x32x16_bf16 v[32:47], v[160:163], v[100:103], v[32:47]
    s_setprio 2
    s_waitcnt lgkmcnt(4)
fk_sbr_13:
    v_readfirstlane_b32 s98, v244
    s_cmp_ge_u32 s98, 16
    s_cbranch_scc1 fk_sbk_14
    ds_read_b32 v244, v242
    s_waitcnt lgkmcnt(0)
    s_branch fk_sbr_13
fk_sbk_14:
    s_setprio 0
    ds_read_b64_tr_b16 v[128:129], v237 offset:12320
    ds_read_b64_tr_b16 v[130:131], v237 offset:13088
    s_add_u32 s63, s96, 8192
    buffer_load_dwordx4 v[96:99], v255, s[28:31], s63 offen sc1
    ds_read_b64_tr_b16 v[132:133], v237 offset:12352
    ds_read_b64_tr_b16 v[134:135], v237 offset:13120
    ds_read_b64_tr_b16 v[136:137], v237 offset:12384
    ds_read_b64_tr_b16 v[138:139], v237 offset:13152
    s_waitcnt lgkmcnt(6)
    v_mfma_f32_32x32x16_bf16 v[48:63], v[164:167], v[100:103], v[48:63]
    v_mfma_f32_32x32x16_bf16 v[64:79], v[168:171], v[100:103], v[64:79]
    s_cbranch_vccz fk_no6_1
    v_mfma_f32_32x32x16_bf16 v[80:95], v[172:175], v[100:103], v[80:95]
fk_no6_1:
    ds_read_b64_tr_b16 v[140:141], v237 offset:12416
    ds_read_b64_tr_b16 v[142:143], v237 offset:13184
    ds_read_b64_tr_b16 v[144:145], v237 offset:12448
    ds_read_b64_tr_b16 v[146:147], v237 offset:13216
    ds_read_b64_tr_b16 v[148:149], v237 offset:12480
    ds_read_b64_tr_b16 v[150:151], v237 offset:13248
    s_mov_b64 exec, 1
    ds_add_u32 v242, v243
    s_mov_b64 exec, -1
    s_waitcnt vmcnt(6)
    s_waitcnt lgkmcnt(7)
    v_mfma_f32_32x32x16_bf16 v[0:15], v[128:131], v[104:107], v[0:15]
    v_mfma_f32_32x32x16_bf16 v[16:31], v[132:135], v[104:107], v[16:31]
    v_mfma_f32_32x32x16_bf16 v[32:47], v[136:139], v[104:107], v[32:47]
    ds_read_b64_tr_b16 v[152:153], v237 offset:15392
    ds_read_b64_tr_b16 v[154:155], v237 offset:16160
    s_add_u32 s63, s96, 9216
    buffer_load_dwordx4 v[100:103], v255, s[28:31], s63 offen sc1
    ds_read_b64_tr_b16 v[156:157], v237 offset:15424
    ds_read_b64_tr_b16 v[158:159], v237 offset:16192
    ds_read_b64_tr_b16 v[160:161], v237 offset:15456
    ds_read_b64_tr_b16 v[162:163], v237 offset:16224
    s_waitcnt lgkmcnt(7)
    v_mfma_f32_32x32x16_bf16 v[48:63], v[140:143], v[104:107], v[48:63]
    v_mfma_f32_32x32x16_bf16 v[64:79], v[144:147], v[104:107], v[64:79]
    s_cbranch_vccz fk_no6_2
    v_mfma_f32_32x32x16_bf16 v[80:95], v[148:151], v[104:107], v[80:95]
fk_no6_2:
    ds_read_b64_tr_b16 v[164:165], v237 offset:15488
    ds_read_b64_tr_b16 v[166:167], v237 offset:16256
    ds_read_b32 v244, v242
    ds_read_b64_tr_b16 v[168:169], v237 offset:15520
    ds_read_b64_tr_b16 v[170:171], v237 offset:16288
    ds_read_b64_tr_b16 v[172:173], v237 offset:15552
    ds_read_b64_tr_b16 v[174:175], v237 offset:16320
    s_waitcnt vmcnt(6)
    s_waitcnt lgkmcnt(7)
    v_mfma_f32_32x32x16_bf16 v[0:15], v[152:155], v[108:111], v[0:15]
    v_mfma_f32_32x32x16_bf16 v[16:31], v[156:159], v[108:111], v[16:31]
    v_mfma_f32_32x32x16_bf16 v[32:47], v[160:163], v[108:111], v[32:47]
    s_setprio 2
    s_waitcnt lgkmcnt(4)
fk_sbr_15:
    v_readfirstlane_b32 s98, v244
    s_cmp_ge_u32 s98, 20
    s_cbranch_scc1 fk_sbk_16
    ds_read_b32 v244, v242
    s_waitcnt lgkmcnt(0)
    s_branch fk_sbr_15
fk_sbk_16:
    s_setprio 0
    ds_read_b64_tr_b16 v[128:129], v237 offset:24640
    ds_read_b64_tr_b16 v[130:131], v237 offset:25408
    s_add_u32 s63, s96, 10240
    buffer_load_dwordx4 v[104:107], v255, s[28:31], s63 offen sc1
    ds_read_b64_tr_b16 v[132:133], v237 offset:24672
    ds_read_b64_tr_b16 v[134:135], v237 offset:25440
    s_add_u32 m0, s97, 61600
    s_add_u32 s62, s95, 440320
    buffer_load_dwordx4 v234, s[40:43], s62 offen lds
    ds_read_b64_tr_b16 v[136:137], v237 offset:24704
    ds_read_b64_tr_b16 v[138:139], v237 offset:25472
    s_add_u32 m0, s97, 62624
    s_add_u32 s62, s95, 440320
    buffer_load_dwordx4 v235, s[40:43], s62 offen lds
    s_waitcnt lgkmcnt(6)
    v_mfma_f32_32x32x16_bf16 v[48:63], v[164:167], v[108:111], v[48:63]
    v_mfma_f32_32x32x16_bf16 v[64:79], v[168:171], v[108:111], v[64:79]
    s_cbranch_vccz fk_no6_3
    v_mfma_f32_32x32x16_bf16 v[80:95], v[172:175], v[108:111], v[80:95]
fk_no6_3:
    ds_read_b64_tr_b16 v[140:141], v237 offset:24736
    ds_read_b64_tr_b16 v[142:143], v237 offset:25504
    s_add_u32 m0, s97, 63648
    s_add_u32 s62, s95, 440320
    buffer_load_dwordx4 v236, s[40:43], s62 offen lds
    ds_read_b64_tr_b16 v[144:145], v237 offset:24768
    ds_read_b64_tr_b16 v[146:147], v237 offset:25536
    ds_read_b64_tr_b16 v[148:149], v237 offset:24800
    ds_read_b64_tr_b16 v[150:151], v237 offset:25568
    s_mov_b64 exec, 1
    ds_add_u32 v242, v243
    s_mov_b64 exec, -1
    s_waitcnt vmcnt(9)
    s_waitcnt lgkmcnt(7)
    v_mfma_f32_32x32x16_bf16 v[0:15], v[128:131], v[112:115], v[0:15]
    v_mfma_f32_32x32x16_bf16 v[16:31], v[132:135], v[112:115], v[16:31]
    v_mfma_f32_32x32x16_bf16 v[32:47], v[136:139], v[112:115], v[32:47]
    ds_read_b64_tr_b16 v[152:153], v237 offset:27712
    ds_read_b64_tr_b16 v[154:155], v237 offset:28480
    s_add_u32 s63, s96, 11264
    buffer_load_dwordx4 v[108:111], v255, s[28:31], s63 offen sc1
    ds_read_b64_tr_b16 v[156:157], v237 offset:27744
    ds_read_b64_tr_b16 v[158:159], v237 offset:28512
    ds_read_b64_tr_b16 v[160:161], v237 offset:27776
    ds_read_b64_tr_b16 v[162:163], v237 offset:28544
    s_waitcnt lgkmcnt(7)
    v_mfma_f32_32x32x16_bf16 v[48:63], v[140:143], v[112:115], v[48:63]
    v_mfma_f32_32x32x16_bf16 v[64:79], v[144:147], v[112:115], v[64:79]
    s_cbranch_vccz fk_no6_4
    v_mfma_f32_32x32x16_bf16 v[80:95], v[148:151], v[112:115], v[80:95]
fk_no6_4:
    ds_read_b64_tr_b16 v[164:165], v237 offset:27808
    ds_read_b64_tr_b16 v[166:167], v237 offset:28576
    ds_read_b32 v244, v242
    ds_read_b64_tr_b16 v[168:169], v237 offset:27840
    ds_read_b64_tr_b16 v[170:171], v237 offset:28608
    ds_read_b64_tr_b16 v[172:173], v237 offset:27872
    ds_read_b64_tr_b16 v[174:175], v237 offset:28640
    s_waitcnt vmcnt(9)
    s_waitcnt lgkmcnt(7)
    v_mfma_f32_32x32x16_bf16 v[0:15], v[152:155], v[116:119], v[0:15]
    v_mfma_f32_32x32x16_bf16 v[16:31], v[156:159], v[116:119], v[16:31]
    v_mfma_f32_32x32x16_bf16 v[32:47], v[160:163], v[116:119], v[32:47]
    s_setprio 2
    s_waitcnt lgkmcnt(4)
fk_sbr_17:
    v_readfirstlane_b32 s98, v244
    s_cmp_ge_u32 s98, 24
    s_cbranch_scc1 fk_sbk_18
    ds_read_b32 v244, v242
    s_waitcnt lgkmcnt(0)
    s_branch fk_sbr_17
fk_sbk_18:
    s_setprio 0
    ds_read_b64_tr_b16 v[128:129], v238 offset:0
    ds_read_b64_tr_b16 v[130:131], v238 offset:768
    s_add_u32 s63, s96, 12288
    buffer_load_dwordx4 v[112:115], v255, s[28:31], s63 offen sc1
    ds_read_b64_tr_b16 v[132:133], v238 offset:32
    ds_read_b64_tr_b16 v[134:135], v238 offset:800
    s_add_u32 m0, s97, 0
    s_add_u32 s62, s95, 528384
    buffer_load_dwordx4 v234, s[40:43], s62 offen lds
    ds_read_b64_tr_b16 v[136:137], v238 offset:64
    ds_read_b64_tr_b16 v[138:139], v238 offset:832
    s_add_u32 m0, s97, 1024
    s_add_u32 s62, s95, 528384
    buffer_load_dwordx4 v235, s[40:43], s62 offen lds
    s_waitcnt lgkmcnt(6)
    v_mfma_f32_32x32x16_bf16 v[48:63], v[164:167], v[116:119], v[48:63]
    v_mfma_f32_32x32x16_bf16 v[64:79], v[168:171], v[116:119], v[64:79]
    s_cbranch_vccz fk_no6_5
    v_mfma_f32_32x32x16_bf16 v[80:95], v[172:175], v[116:119], v[80:95]
fk_no6_5:
    ds_read_b64_tr_b16 v[140:141], v238 offset:96
    ds_read_b64_tr_b16 v[142:143], v238 offset:864
    s_add_u32 m0, s97, 2048
    s_add_u32 s62, s95, 528384
    buffer_load_dwordx4 v236, s[40:43], s62 offen lds
    ds_read_b64_tr_b16 v[144:145], v238 offset:128
    ds_read_b64_tr_b16 v[146:147], v238 offset:896
    ds_read_b64_tr_b16 v[148:149], v238 offset:160
    ds_read_b64_tr_b16 v[150:151], v238 offset:928
    s_mov_b64 exec, 1
    ds_add_u32 v242, v243
    s_mov_b64 exec, -1
    s_waitcnt vmcnt(12)
    s_waitcnt lgkmcnt(7)
    v_mfma_f32_32x32x16_bf16 v[0:15], v[128:131], v[120:123], v[0:15]
    v_mfma_f32_32x32x16_bf16 v[16:31], v[132:135], v[120:123], v[16:31]
    v_mfma_f32_32x32x16_bf16 v[32:47], v[136:139], v[120:123], v[32:47]
    ds_read_b64_tr_b16 v[152:153], v238 offset:3072
    ds_read_b64_tr_b16 v[154:155], v238 offset:3840
    s_add_u32 s63, s96, 13312
    buffer_load_dwordx4 v[116:119], v255, s[28:31], s63 offen sc1
    ds_read_b64_tr_b16 v[156:157], v238 offset:3104
    ds_read_b64_tr_b16 v[158:159], v238 offset:3872
    ds_read_b64_tr_b16 v[160:161], v238 offset:3136
    ds_read_b64_tr_b16 v[162:163], v238 offset:3904
    s_waitcnt lgkmcnt(7)
    v_mfma_f32_32x32x16_bf16 v[48:63], v[140:143], v[120:123], v[48:63]
    v_mfma_f32_32x32x16_bf16 v[64:79], v[144:147], v[120:123], v[64:79]
    s_cbranch_vccz fk_no6_6
    v_mfma_f32_32x32x16_bf16 v[80:95], v[148:151], v[120:123], v[80:95]
fk_no6_6:
    ds_read_b64_tr_b16 v[164:165], v238 offset:3168
    ds_read_b64_tr_b16 v[166:167], v238 offset:3936
    ds_read_b32 v244, v242
    ds_read_b64_tr_b16 v[168:169], v238 offset:3200
    ds_read_b64_tr_b16 v[170:171], v238 offset:3968
    ds_read_b64_tr_b16 v[172:173], v238 offset:3232
    ds_read_b64_tr_b16 v[174:175], v238 offset:4000
    s_waitcnt vmcnt(12)
    s_waitcnt lgkmcnt(7)
    v_mfma_f32_32x32x16_bf16 v[0:15], v[152:155], v[124:127], v[0:15]
    v_mfma_f32_32x32x16_bf16 v[16:31], v[156:159], v[124:127], v[16:31]
    v_mfma_f32_32x32x16_bf16 v[32:47], v[160:163], v[124:127], v[32:47]
    s_setprio 2
    s_waitcnt lgkmcnt(4)
fk_sbr_19:
    v_readfirstlane_b32 s98, v244
    s_cmp_ge_u32 s98, 28
    s_cbranch_scc1 fk_sbk_20
    ds_read_b32 v244, v242
    s_waitcnt lgkmcnt(0)
    s_branch fk_sbr_19
fk_sbk_20:
    s_setprio 0
    ds_read_b64_tr_b16 v[128:129], v238 offset:12320
    ds_read_b64_tr_b16 v[130:131], v238 offset:13088
    s_add_u32 s63, s96, 14336
    buffer_load_dwordx4 v[120:123], v255, s[28:31], s63 offen sc1
    ds_read_b64_tr_b16 v[132:133], v238 offset:12352
    ds_read_b64_tr_b16 v[134:135], v238 offset:13120
    s_add_u32 m0, s97, 12320
    s_add_u32 s62, s95, 616448
    buffer_load_dwordx4 v234, s[40:43], s62 offen lds
    ds_read_b64_tr_b16 v[136:137], v238 offset:12384
    ds_read_b64_tr_b16 v[138:139], v238 offset:13152
    s_add_u32 m0, s97, 13344
    s_add_u32 s62, s95, 616448
    buffer_load_dwordx4 v235, s[40:43], s62 offen lds
    s_waitcnt lgkmcnt(6)
    v_mfma_f32_32x32x16_bf16 v[48:63], v[164:167], v[124:127], v[48:63]
    v_mfma_f32_32x32x16_bf16 v[64:79], v[168:171], v[124:127], v[64:79]
    s_cbranch_vccz fk_no6_7
    v_mfma_f32_32x32x16_bf16 v[80:95], v[172:175], v[124:127], v[80:95]
fk_no6_7:
    ds_read_b64_tr_b16 v[140:141], v238 offset:12416
    ds_read_b64_tr_b16 v[142:143], v238 offset:13184
    s_add_u32 m0, s97, 14368
    s_add_u32 s62, s95, 616448
    buffer_load_dwordx4 v236, s[40:43], s62 offen lds
    ds_read_b64_tr_b16 v[144:145], v238 offset:12448
    ds_read_b64_tr_b16 v[146:147], v238 offset:13216
    ds_read_b64_tr_b16 v[148:149], v238 offset:12480
    ds_read_b64_tr_b16 v[150:151], v238 offset:13248
    s_waitcnt vmcnt(10)
    s_mov_b64 exec, 1
    ds_add_u32 v242, v243
    s_mov_b64 exec, -1
    s_waitcnt lgkmcnt(7)
    v_mfma_f32_32x32x16_bf16 v[0:15], v[128:131], v[96:99], v[0:15]
    v_mfma_f32_32x32x16_bf16 v[16:31], v[132:135], v[96:99], v[16:31]
    v_mfma_f32_32x32x16_bf16 v[32:47], v[136:139], v[96:99], v[32:47]
    ds_read_b64_tr_b16 v[152:153], v238 offset:15392
    ds_read_b64_tr_b16 v[154:155], v238 offset:16160
    s_add_u32 s63, s96, 15360
    buffer_load_dwordx4 v[124:127], v255, s[28:31], s63 offen sc1
    ds_read_b64_tr_b16 v[156:157], v238 offset:15424
    ds_read_b64_tr_b16 v[158:159], v238 offset:16192
    ds_read_b64_tr_b16 v[160:161], v238 offset:15456
    ds_read_b64_tr_b16 v[162:163], v238 offset:16224
    s_waitcnt lgkmcnt(7)
    v_mfma_f32_32x32x16_bf16 v[48:63], v[140:143], v[96:99], v[48:63]
    v_mfma_f32_32x32x16_bf16 v[64:79], v[144:147], v[96:99], v[64:79]
    s_cbranch_vccz fk_no6_8
    v_mfma_f32_32x32x16_bf16 v[80:95], v[148:151], v[96:99], v[80:95]
fk_no6_8:
    ds_read_b64_tr_b16 v[164:165], v238 offset:15488
    ds_read_b64_tr_b16 v[166:167], v238 offset:16256
    ds_read_b32 v244, v242
    ds_read_b64_tr_b16 v[168:169], v238 offset:15520
    ds_read_b64_tr_b16 v[170:171], v238 offset:16288
    ds_read_b64_tr_b16 v[172:173], v238 offset:15552
    ds_read_b64_tr_b16 v[174:175], v238 offset:16320
    s_waitcnt lgkmcnt(7)
    v_mfma_f32_32x32x16_bf16 v[0:15], v[152:155], v[100:103], v[0:15]
    v_mfma_f32_32x32x16_bf16 v[16:31], v[156:159], v[100:103], v[16:31]
    v_mfma_f32_32x32x16_bf16 v[32:47], v[160:163], v[100:103], v[32:47]
    s_setprio 2
    s_waitcnt lgkmcnt(4)
fk_sbr_21:
    v_readfirstlane_b32 s98, v244
    s_cmp_ge_u32 s98, 32
    s_cbranch_scc1 fk_sbk_22
    ds_read_b32 v244, v242
    s_waitcnt lgkmcnt(0)
    s_branch fk_sbr_21
fk_sbk_22:
    s_setprio 0
    ds_read_b64_tr_b16 v[128:129], v238 offset:24640
    ds_read_b64_tr_b16 v[130:131], v238 offset:25408
    s_add_u32 s63, s96, 16384
    buffer_load_dwordx4 v[96:99], v255, s[28:31], s63 offen sc1
    ds_read_b64_tr_b16 v[132:133], v238 offset:24672
    ds_read_b64_tr_b16 v[134:135], v238 offset:25440
    s_add_u32 m0, s97, 24640
    s_add_u32 s62, s95, 704512
    buffer_load_dwordx4 v234, s[40:43], s62 offen lds
    ds_read_b64_tr_b16 v[136:137], v238 offset:24704
    ds_read_b64_tr_b16 v[138:139], v238 offset:25472
    s_add_u32 m0, s97, 25664
    s_add_u32 s62, s95, 704512
    buffer_load_dwordx4 v235, s[40:43], s62 offen lds
    s_waitcnt lgkmcnt(6)
    v_mfma_f32_32x32x16_bf16 v[48:63], v[164:167], v[100:103], v[48:63]
    v_mfma_f32_32x32x16_bf16 v[64:79], v[168:171], v[100:103], v[64:79]
    s_cbranch_vccz fk_no6_9
    v_mfma_f32_32x32x16_bf16 v[80:95], v[172:175], v[100:103], v[80:95]
fk_no6_9:
    ds_read_b64_tr_b16 v[140:141], v238 offset:24736
    ds_read_b64_tr_b16 v[142:143], v238 offset:25504
    s_add_u32 m0, s97, 26688
    s_add_u32 s62, s95, 704512
    buffer_load_dwordx4 v236, s[40:43], s62 offen lds
    ds_read_b64_tr_b16 v[144:145], v238 offset:24768
    ds_read_b64_tr_b16 v[146:147], v238 offset:25536
    ds_read_b64_tr_b16 v[148:149], v238 offset:24800
    ds_read_b64_tr_b16 v[150:151], v238 offset:25568
    s_waitcnt vmcnt(10)
    s_mov_b64 exec, 1
    ds_add_u32 v242, v243
    s_mov_b64 exec, -1
    s_waitcnt lgkmcnt(7)
    v_mfma_f32_32x32x16_bf16 v[0:15], v[128:131], v[104:107], v[0:15]
    v_mfma_f32_32x32x16_bf16 v[16:31], v[132:135], v[104:107], v[16:31]
    v_mfma_f32_32x32x16_bf16 v[32:47], v[136:139], v[104:107], v[32:47]
    ds_read_b64_tr_b16 v[152:153], v238 offset:27712
    ds_read_b64_tr_b16 v[154:155], v238 offset:28480
    s_add_u32 s63, s96, 17408
    buffer_load_dwordx4 v[100:103], v255, s[28:31], s63 offen sc1
    ds_read_b64_tr_b16 v[156:157], v238 offset:27744
    ds_read_b64_tr_b16 v[158:159], v238 offset:28512
    ds_read_b64_tr_b16 v[160:161], v238 offset:27776
    ds_read_b64_tr_b16 v[162:163], v238 offset:28544
    s_waitcnt lgkmcnt(7)
    v_mfma_f32_32x32x16_bf16 v[48:63], v[140:143], v[104:107], v[48:63]
    v_mfma_f32_32x32x16_bf16 v[64:79], v[144:147], v[104:107], v[64:79]
    s_cbranch_vccz fk_no6_10
    v_mfma_f32_32x32x16_bf16 v[80:95], v[148:151], v[104:107], v[80:95]
fk_no6_10:
    ds_read_b64_tr_b16 v[164:165], v238 offset:27808
    ds_read_b64_tr_b16 v[166:167], v238 offset:28576
    ds_read_b32 v244, v242
    ds_read_b64_tr_b16 v[168:169], v238 offset:27840
    ds_read_b64_tr_b16 v[170:171], v238 offset:28608
    ds_read_b64_tr_b16 v[172:173], v238 offset:27872
    ds_read_b64_tr_b16 v[174:175], v238 offset:28640
    s_waitcnt lgkmcnt(7)
    v_mfma_f32_32x32x16_bf16 v[0:15], v[152:155], v[108:111], v[0:15]
    v_mfma_f32_32x32x16_bf16 v[16:31], v[156:159], v[108:111], v[16:31]
    v_mfma_f32_32x32x16_bf16 v[32:47], v[160:163], v[108:111], v[32:47]
    s_setprio 2
    s_waitcnt lgkmcnt(4)
fk_sbr_23:
    v_readfirstlane_b32 s98, v244
    s_cmp_ge_u32 s98, 36
    s_cbranch_scc1 fk_sbk_24
    ds_read_b32 v244, v242
    s_waitcnt lgkmcnt(0)
    s_branch fk_sbr_23
fk_sbk_24:
    s_setprio 0
    ds_read_b64_tr_b16 v[128:129], v237 offset:0
    ds_read_b64_tr_b16 v[130:131], v237 offset:768
    s_add_u32 s63, s96, 18432
    buffer_load_dwordx4 v[104:107], v255, s[28:31], s63 offen sc1
    ds_read_b64_tr_b16 v[132:133], v237 offset:32
    ds_read_b64_tr_b16 v[134:135], v237 offset:800
    s_add_u32 m0, s97, 36960
    s_add_u32 s62, s95, 792576
    buffer_load_dwordx4 v234, s[40:43], s62 offen lds
    ds_read_b64_tr_b16 v[136:137], v237 offset:64
    ds_read_b64_tr_b16 v[138:139], v237 offset:832
    s_add_u32 m0, s97, 37984
    s_add_u32 s62, s95, 792576
    buffer_load_dwordx4 v235, s[40:43], s62 offen lds
    s_waitcnt lgkmcnt(6)
    v_mfma_f32_32x32x16_bf16 v[48:63], v[164:167], v[108:111], v[48:63]
    v_mfma_f32_32x32x16_bf16 v[64:79], v[168:171], v[108:111], v[64:79]
    s_cbranch_vccz fk_no6_11
    v_mfma_f32_32x32x16_bf16 v[80:95], v[172:175], v[108:111], v[80:95]
fk_no6_11:
    ds_read_b64_tr_b16 v[140:141], v237 offset:96
    ds_read_b64_tr_b16 v[142:143], v237 offset:864
    s_add_u32 m0, s97, 39008
    s_add_u32 s62, s95, 792576
    buffer_load_dwordx4 v236, s[40:43], s62 offen lds
    ds_read_b64_tr_b16 v[144:145], v237 offset:128
    ds_read_b64_tr_b16 v[146:147], v237 offset:896
    ds_read_b64_tr_b16 v[148:149], v237 offset:160
    ds_read_b64_tr_b16 v[150:151], v237 offset:928
    s_waitcnt vmcnt(10)
    s_mov_b64 exec, 1
    ds_add_u32 v242, v243
    s_mov_b64 exec, -1
    s_waitcnt lgkmcnt(7)
    v_mfma_f32_32x32x16_bf16 v[0:15], v[128:131], v[112:115], v[0:15]
    v_mfma_f32_32x32x16_bf16 v[16:31], v[132:135], v[112:115], v[16:31]
    v_mfma_f32_32x32x16_bf16 v[32:47], v[136:139], v[112:115], v[32:47]
    ds_read_b64_tr_b16 v[152:153], v237 offset:3072
    ds_read_b64_tr_b16 v[154:155], v237 offset:3840
    s_add_u32 s63, s96, 19456
    buffer_load_dwordx4 v[108:111], v255, s[28:31], s63 offen sc1
    ds_read_b64_tr_b16 v[156:157], v237 offset:3104
    ds_read_b64_tr_b16 v[158:159], v237 offset:3872
    ds_read_b64_tr_b16 v[160:161], v237 offset:3136
    ds_read_b64_tr_b16 v[162:163], v237 offset:3904
    s_waitcnt lgkmcnt(7)
    v_mfma_f32_32x32x16_bf16 v[48:63], v[140:143], v[112:115], v[48:63]
    v_mfma_f32_32x32x16_bf16 v[64:79], v[144:147], v[112:115], v[64:79]
    s_cbranch_vccz fk_no6_12
    v_mfma_f32_32x32x16_bf16 v[80:95], v[148:151], v[112:115], v[80:95]
fk_no6_12:
    ds_read_b64_tr_b16 v[164:165], v237 offset:3168
    ds_read_b64_tr_b16 v[166:167], v237 offset:3936
    ds_read_b32 v244, v242
    ds_read_b64_tr_b16 v[168:169], v237 offset:3200
    ds_read_b64_tr_b16 v[170:171], v237 offset:3968
    ds_read_b64_tr_b16 v[172:173], v237 offset:3232
    ds_read_b64_tr_b16 v[174:175], v237 offset:4000
    s_waitcnt lgkmcnt(7)
    v_mfma_f32_32x32x16_bf16 v[0:15], v[152:155], v[116:119], v[0:15]
    v_mfma_f32_32x32x16_bf16 v[16:31], v[156:159], v[116:119], v[16:31]
    v_mfma_f32_32x32x16_bf16 v[32:47], v[160:163], v[116:119], v[32:47]
    s_setprio 2
    s_waitcnt lgkmcnt(4)
fk_sbr_25:
    v_readfirstlane_b32 s98, v244
    s_cmp_ge_u32 s98, 40
    s_cbranch_scc1 fk_sbk_26
    ds_read_b32 v244, v242
    s_waitcnt lgkmcnt(0)
    s_branch fk_sbr_25
fk_sbk_26:
    s_setprio 0
    ds_read_b64_tr_b16 v[128:129], v237 offset:12320
    ds_read_b64_tr_b16 v[130:131], v237 offset:13088
    s_add_u32 s63, s96, 20480
    buffer_load_dwordx4 v[112:115], v255, s[28:31], s63 offen sc1
    ds_read_b64_tr_b16 v[132:133], v237 offset:12352
    ds_read_b64_tr_b16 v[134:135], v237 offset:13120
    s_add_u32 m0, s97, 49280
    s_add_u32 s62, s95, 880640
    buffer_load_dwordx4 v234, s[40:43], s62 offen lds
    ds_read_b64_tr_b16 v[136:137], v237 offset:12384
    ds_read_b64_tr_b16 v[138:139], v237 offset:13152
    s_add_u32 m0, s97, 50304
    s_add_u32 s62, s95, 880640
    buffer_load_dwordx4 v235, s[40:43], s62 offen lds
    s_waitcnt lgkmcnt(6)
    v_mfma_f32_32x32x16_bf16 v[48:63], v[164:167], v[116:119], v[48:63]
    v_mfma_f32_32x32x16_bf16 v[64:79], v[168:171], v[116:119], v[64:79]
    s_cbranch_vccz fk_no6_13
    v_mfma_f32_32x32x16_bf16 v[80:95], v[172:175], v[116:119], v[80:95]
fk_no6_13:
    ds_read_b64_tr_b16 v[140:141], v237 offset:12416
    ds_read_b64_tr_b16 v[142:143], v237 offset:13184
    s_add_u32 m0, s97, 51328
    s_add_u32 s62, s95, 880640
    buffer_load_dwordx4 v236, s[40:43], s62 offen lds
    ds_read_b64_tr_b16 v[144:145], v237 offset:12448
    ds_read_b64_tr_b16 v[146:147], v237 offset:13216
    ds_read_b64_tr_b16 v[148:149], v237 offset:12480
    ds_read_b64_tr_b16 v[150:151], v237 offset:13248
    s_waitcnt vmcnt(10)
    s_mov_b64 exec, 1
    ds_add_u32 v242, v243
    s_mov_b64 exec, -1
    s_waitcnt lgkmcnt(7)
    v_mfma_f32_32x32x16_bf16 v[0:15], v[128:131], v[120:123], v[0:15]
    v_mfma_f32_32x32x16_bf16 v[16:31], v[132:135], v[120:123], v[16:31]
    v_mfma_f32_32x32x16_bf16 v[32:47], v[136:139], v[120:123], v[32:47]
    ds_read_b64_tr_b16 v[152:153], v237 offset:15392
    ds_read_b64_tr_b16 v[154:155], v237 offset:16160
    s_add_u32 s63, s96, 21504
    buffer_load_dwordx4 v[116:119], v255, s[28:31], s63 offen sc1
    ds_read_b64_tr_b16 v[156:157], v237 offset:15424
    ds_read_b64_tr_b16 v[158:159], v237 offset:16192
    ds_read_b64_tr_b16 v[160:161], v237 offset:15456
    ds_read_b64_tr_b16 v[162:163], v237 offset:16224
    s_waitcnt lgkmcnt(7)
    v_mfma_f32_32x32x16_bf16 v[48:63], v[140:143], v[120:123], v[48:63]
    v_mfma_f32_32x32x16_bf16 v[64:79], v[144:147], v[120:123], v[64:79]
    s_cbranch_vccz fk_no6_14
    v_mfma_f32_32x32x16_bf16 v[80:95], v[148:151], v[120:123], v[80:95]
fk_no6_14:
    ds_read_b64_tr_b16 v[164:165], v237 offset:15488
    ds_read_b64_tr_b16 v[166:167], v237 offset:16256
    ds_read_b32 v244, v242
    ds_read_b64_tr_b16 v[168:169], v237 offset:15520
    ds_read_b64_tr_b16 v[170:171], v237 offset:16288
    ds_read_b64_tr_b16 v[172:173], v237 offset:15552
    ds_read_b64_tr_b16 v[174:175], v237 offset:16320
    s_waitcnt lgkmcnt(7)
    v_mfma_f32_32x32x16_bf16 v[0:15], v[152:155], v[124:127], v[0:15]
    v_mfma_f32_32x32x16_bf16 v[16:31], v[156:159], v[124:127], v[16:31]
    v_mfma_f32_32x32x16_bf16 v[32:47], v[160:163], v[124:127], v[32:47]
    s_setprio 2
    s_waitcnt lgkmcnt(4)
fk_sbr_27:
    v_readfirstlane_b32 s98, v244
    s_cmp_ge_u32 s98, 44
    s_cbranch_scc1 fk_sbk_28
    ds_read_b32 v244, v242
    s_waitcnt lgkmcnt(0)
    s_branch fk_sbr_27
fk_sbk_28:
    s_setprio 0
    ds_read_b64_tr_b16 v[128:129], v237 offset:24640
    ds_read_b64_tr_b16 v[130:131], v237 offset:25408
    s_add_u32 s63, s96, 22528
    buffer_load_dwordx4 v[120:123], v255, s[28:31], s63 offen sc1
    ds_read_b64_tr_b16 v[132:133], v237 offset:24672
    ds_read_b64_tr_b16 v[134:135], v237 offset:25440
    s_add_u32 m0, s97, 61600
    s_add_u32 s62, s95, 968704
    buffer_load_dwordx4 v234, s[40:43], s62 offen lds
    ds_read_b64_tr_b16 v[136:137], v237 offset:24704
    ds_read_b64_tr_b16 v[138:139], v237 offset:25472
    s_add_u32 m0, s97, 62624
    s_add_u32 s62, s95, 968704
    buffer_load_dwordx4 v235, s[40:43], s62 offen lds
    s_waitcnt lgkmcnt(6)
    v_mfma_f32_32x32x16_bf16 v[48:63], v[164:167], v[124:127], v[48:63]
    v_mfma_f32_32x32x16_bf16 v[64:79], v[168:171], v[124:127], v[64:79]
    s_cbranch_vccz fk_no6_15
    v_mfma_f32_32x32x16_bf16 v[80:95], v[172:175], v[124:127], v[80:95]
fk_no6_15:
    ds_read_b64_tr_b16 v[140:141], v237 offset:24736
    ds_read_b64_tr_b16 v[142:143], v237 offset:25504
    s_add_u32 m0, s97, 63648
    s_add_u32 s62, s95, 968704
    buffer_load_dwordx4 v236, s[40:43], s62 offen lds
    ds_read_b64_tr_b16 v[144:145], v237 offset:24768
    ds_read_b64_tr_b16 v[146:147], v237 offset:25536
    ds_read_b64_tr_b16 v[148:149], v237 offset:24800
    ds_read_b64_tr_b16 v[150:151], v237 offset:25568
    s_waitcnt vmcnt(10)
    s_mov_b64 exec, 1
    ds_add_u32 v242, v243
    s_mov_b64 exec, -1
    s_waitcnt lgkmcnt(7)
    v_mfma_f32_32x32x16_bf16 v[0:15], v[128:131], v[96:99], v[0:15]
    v_mfma_f32_32x32x16_bf16 v[16:31], v[132:135], v[96:99], v[16:31]
    v_mfma_f32_32x32x16_bf16 v[32:47], v[136:139], v[96:99], v[32:47]
    ds_read_b64_tr_b16 v[152:153], v237 offset:27712
    ds_read_b64_tr_b16 v[154:155], v237 offset:28480
    s_add_u32 s63, s96, 23552
    buffer_load_dwordx4 v[124:127], v255, s[28:31], s63 offen sc1
    ds_read_b64_tr_b16 v[156:157], v237 offset:27744
    ds_read_b64_tr_b16 v[158:159], v237 offset:28512
    ds_read_b64_tr_b16 v[160:161], v237 offset:27776
    ds_read_b64_tr_b16 v[162:163], v237 offset:28544
    s_waitcnt lgkmcnt(7)
    v_mfma_f32_32x32x16_bf16 v[48:63], v[140:143], v[96:99], v[48:63]
    v_mfma_f32_32x32x16_bf16 v[64:79], v[144:147], v[96:99], v[64:79]
    s_cbranch_vccz fk_no6_16
    v_mfma_f32_32x32x16_bf16 v[80:95], v[148:151], v[96:99], v[80:95]
fk_no6_16:
    ds_read_b64_tr_b16 v[164:165], v237 offset:27808
    ds_read_b64_tr_b16 v[166:167], v237 offset:28576
    ds_read_b32 v244, v242
    ds_read_b64_tr_b16 v[168:169], v237 offset:27840
    ds_read_b64_tr_b16 v[170:171], v237 offset:28608
    ds_read_b64_tr_b16 v[172:173], v237 offset:27872
    ds_read_b64_tr_b16 v[174:175], v237 offset:28640
    s_waitcnt lgkmcnt(7)
    v_mfma_f32_32x32x16_bf16 v[0:15], v[152:155], v[100:103], v[0:15]
    v_mfma_f32_32x32x16_bf16 v[16:31], v[156:159], v[100:103], v[16:31]
    v_mfma_f32_32x32x16_bf16 v[32:47], v[160:163], v[100:103], v[32:47]
    s_setprio 2
    s_waitcnt lgkmcnt(4)
fk_sbr_29:
    v_readfirstlane_b32 s98, v244
    s_cmp_ge_u32 s98, 48
    s_cbranch_scc1 fk_sbk_30
    ds_read_b32 v244, v242
    s_waitcnt lgkmcnt(0)
    s_branch fk_sbr_29
fk_sbk_30:
    s_setprio 0
    ds_read_b64_tr_b16 v[128:129], v238 offset:0
    ds_read_b64_tr_b16 v[130:131], v238 offset:768
    s_add_u32 s63, s96, 24576
    buffer_load_dwordx4 v[96:99], v255, s[28:31], s63 offen sc1
    ds_read_b64_tr_b16 v[132:133], v238 offset:32
    ds_read_b64_tr_b16 v[134:135], v238 offset:800
    s_add_u32 m0, s97, 0
    s_add_u32 s62, s95, 1056768
    buffer_load_dwordx4 v234, s[40:43], s62 offen lds
    ds_read_b64_tr_b16 v[136:137], v238 offset:64
    ds_read_b64_tr_b16 v[138:139], v238 offset:832
    s_add_u32 m0, s97, 1024
    s_add_u32 s62, s95, 1056768
    buffer_load_dwordx4 v235, s[40:43], s62 offen lds
    s_waitcnt lgkmcnt(6)
    v_mfma_f32_32x32x16_bf16 v[48:63], v[164:167], v[100:103], v[48:63]
    v_mfma_f32_32x32x16_bf16 v[64:79], v[168:171], v[100:103], v[64:79]
    s_cbranch_vccz fk_no6_17
    v_mfma_f32_32x32x16_bf16 v[80:95], v[172:175], v[100:103], v[80:95]
fk_no6_17:
    ds_read_b64_tr_b16 v[140:141], v238 offset:96
    ds_read_b64_tr_b16 v[142:143], v238 offset:864
    s_add_u32 m0, s97, 2048
    s_add_u32 s62, s95, 1056768
    buffer_load_dwordx4 v236, s[40:43], s62 offen lds
    ds_read_b64_tr_b16 v[144:145], v238 offset:128
    ds_read_b64_tr_b16 v[146:147], v238 offset:896
    ds_read_b64_tr_b16 v[148:149], v238 offset:160
    ds_read_b64_tr_b16 v[150:151], v238 offset:928
    s_waitcnt vmcnt(10)
    s_mov_b64 exec, 1
    ds_add_u32 v242, v243
    s_mov_b64 exec, -1
    s_waitcnt lgkmcnt(7)
    v_mfma_f32_32x32x16_bf16 v[0:15], v[128:131], v[104:107], v[0:15]
    v_mfma_f32_32x32x16_bf16 v[16:31], v[132:135], v[104:107], v[16:31]
    v_mfma_f32_32x32x16_bf16 v[32:47], v[136:139], v[104:107], v[32:47]
    ds_read_b64_tr_b16 v[152:153], v238 offset:3072
    ds_read_b64_tr_b16 v[154:155], v238 offset:3840
    s_add_u32 s63, s96, 25600
    buffer_load_dwordx4 v[100:103], v255, s[28:31], s63 offen sc1
    ds_read_b64_tr_b16 v[156:157], v238 offset:3104
    ds_read_b64_tr_b16 v[158:159], v238 offset:3872
    ds_read_b64_tr_b16 v[160:161], v238 offset:3136
    ds_read_b64_tr_b16 v[162:163], v238 offset:3904
    s_waitcnt lgkmcnt(7)
    v_mfma_f32_32x32x16_bf16 v[48:63], v[140:143], v[104:107], v[48:63]
    v_mfma_f32_32x32x16_bf16 v[64:79], v[144:147], v[104:107], v[64:79]
    s_cbranch_vccz fk_no6_18
    v_mfma_f32_32x32x16_bf16 v[80:95], v[148:151], v[104:107], v[80:95]
fk_no6_18:
    ds_read_b64_tr_b16 v[164:165], v238 offset:3168
    ds_read_b64_tr_b16 v[166:167], v238 offset:3936
    ds_read_b32 v244, v242
    ds_read_b64_tr_b16 v[168:169], v238 offset:3200
    ds_read_b64_tr_b16 v[170:171], v238 offset:3968
    ds_read_b64_tr_b16 v[172:173], v238 offset:3232
    ds_read_b64_tr_b16 v[174:175], v238 offset:4000
    s_waitcnt lgkmcnt(7)
    v_mfma_f32_32x32x16_bf16 v[0:15], v[152:155], v[108:111], v[0:15]
    v_mfma_f32_32x32x16_bf16 v[16:31], v[156:159], v[108:111], v[16:31]
    v_mfma_f32_32x32x16_bf16 v[32:47], v[160:163], v[108:111], v[32:47]
    s_setprio 2
    s_waitcnt lgkmcnt(4)
fk_sbr_31:
    v_readfirstlane_b32 s98, v244
    s_cmp_ge_u32 s98, 52
    s_cbranch_scc1 fk_sbk_32
    ds_read_b32 v244, v242
    s_waitcnt lgkmcnt(0)
    s_branch fk_sbr_31
fk_sbk_32:
    s_setprio 0
    ds_read_b64_tr_b16 v[128:129], v238 offset:12320
    ds_read_b64_tr_b16 v[130:131], v238 offset:13088
    s_add_u32 s63, s96, 26624
    buffer_load_dwordx4 v[104:107], v255, s[28:31], s63 offen sc1
    ds_read_b64_tr_b16 v[132:133], v238 offset:12352
    ds_read_b64_tr_b16 v[134:135], v238 offset:13120
    s_add_u32 m0, s97, 12320
    s_add_u32 s62, s95, 1144832
    buffer_load_dwordx4 v234, s[40:43], s62 offen lds
    ds_read_b64_tr_b16 v[136:137], v238 offset:12384
    ds_read_b64_tr_b16 v[138:139], v238 offset:13152
    s_add_u32 m0, s97, 13344
    s_add_u32 s62, s95, 1144832
    buffer_load_dwordx4 v235, s[40:43], s62 offen lds
    s_waitcnt lgkmcnt(6)
    v_mfma_f32_32x32x16_bf16 v[48:63], v[164:167], v[108:111], v[48:63]
    v_mfma_f32_32x32x16_bf16 v[64:79], v[168:171], v[108:111], v[64:79]
    s_cbranch_vccz fk_no6_19
    v_mfma_f32_32x32x16_bf16 v[80:95], v[172:175], v[108:111], v[80:95]
fk_no6_19:
    ds_read_b64_tr_b16 v[140:141], v238 offset:12416
    ds_read_b64_tr_b16 v[142:143], v238 offset:13184
    s_add_u32 m0, s97, 14368
    s_add_u32 s62, s95, 1144832
    buffer_load_dwordx4 v236, s[40:43], s62 offen lds
    ds_read_b64_tr_b16 v[144:145], v238 offset:12448
    ds_read_b64_tr_b16 v[146:147], v238 offset:13216
    ds_read_b64_tr_b16 v[148:149], v238 offset:12480
    ds_read_b64_tr_b16 v[150:151], v238 offset:13248
    s_waitcnt vmcnt(10)
    s_mov_b64 exec, 1
    ds_add_u32 v242, v243
    s_mov_b64 exec, -1
    s_waitcnt lgkmcnt(7)
    v_mfma_f32_32x32x16_bf16 v[0:15], v[128:131], v[112:115], v[0:15]
    v_mfma_f32_32x32x16_bf16 v[16:31], v[132:135], v[112:115], v[16:31]
    v_mfma_f32_32x32x16_bf16 v[32:47], v[136:139], v[112:115], v[32:47]
    ds_read_b64_tr_b16 v[152:153], v238 offset:15392
    ds_read_b64_tr_b16 v[154:155], v238 offset:16160
    s_add_u32 s63, s96, 27648
    buffer_load_dwordx4 v[108:111], v255, s[28:31], s63 offen sc1
    ds_read_b64_tr_b16 v[156:157], v238 offset:15424
    ds_read_b64_tr_b16 v[158:159], v238 offset:16192
    ds_read_b64_tr_b16 v[160:161], v238 offset:15456
    ds_read_b64_tr_b16 v[162:163], v238 offset:16224
    s_waitcnt lgkmcnt(7)
    v_mfma_f32_32x32x16_bf16 v[48:63], v[140:143], v[112:115], v[48:63]
    v_mfma_f32_32x32x16_bf16 v[64:79], v[144:147], v[112:115], v[64:79]
    s_cbranch_vccz fk_no6_20
    v_mfma_f32_32x32x16_bf16 v[80:95], v[148:151], v[112:115], v[80:95]
fk_no6_20:
    ds_read_b64_tr_b16 v[164:165], v238 offset:15488
    ds_read_b64_tr_b16 v[166:167], v238 offset:16256
    ds_read_b32 v244, v242
    ds_read_b64_tr_b16 v[168:169], v238 offset:15520
    ds_read_b64_tr_b16 v[170:171], v238 offset:16288
    ds_read_b64_tr_b16 v[172:173], v238 offset:15552
    ds_read_b64_tr_b16 v[174:175], v238 offset:16320
    s_waitcnt lgkmcnt(7)
    v_mfma_f32_32x32x16_bf16 v[0:15], v[152:155], v[116:119], v[0:15]
    v_mfma_f32_32x32x16_bf16 v[16:31], v[156:159], v[116:119], v[16:31]
    v_mfma_f32_32x32x16_bf16 v[32:47], v[160:163], v[116:119], v[32:47]
    s_setprio 2
    s_waitcnt lgkmcnt(4)
fk_sbr_33:
    v_readfirstlane_b32 s98, v244
    s_cmp_ge_u32 s98, 56
    s_cbranch_scc1 fk_sbk_34
    ds_read_b32 v244, v242
    s_waitcnt lgkmcnt(0)
    s_branch fk_sbr_33
fk_sbk_34:
    s_setprio 0
    ds_read_b64_tr_b16 v[128:129], v238 offset:24640
    ds_read_b64_tr_b16 v[130:131], v238 offset:25408
    s_add_u32 s63, s96, 28672
    buffer_load_dwordx4 v[112:115], v255, s[28:31], s63 offen sc1
    ds_read_b64_tr_b16 v[132:133], v238 offset:24672
    ds_read_b64_tr_b16 v[134:135], v238 offset:25440
    s_add_u32 m0, s97, 24640
    s_add_u32 s62, s95, 1232896
    buffer_load_dwordx4 v234, s[40:43], s62 offen lds
    ds_read_b64_tr_b16 v[136:137], v238 offset:24704
    ds_read_b64_tr_b16 v[138:139], v238 offset:25472
    s_add_u32 m0, s97, 25664
    s_add_u32 s62, s95, 1232896
    buffer_load_dwordx4 v235, s[40:43], s62 offen lds
    s_waitcnt lgkmcnt(6)
    v_mfma_f32_32x32x16_bf16 v[48:63], v[164:167], v[116:119], v[48:63]
    v_mfma_f32_32x32x16_bf16 v[64:79], v[168:171], v[116:119], v[64:79]
    s_cbranch_vccz fk_no6_21
    v_mfma_f32_32x32x16_bf16 v[80:95], v[172:175], v[116:119], v[80:95]
fk_no6_21:
    ds_read_b64_tr_b16 v[140:141], v238 offset:24736
    ds_read_b64_tr_b16 v[142:143], v238 offset:25504
    s_add_u32 m0, s97, 26688
    s_add_u32 s62, s95, 1232896
    buffer_load_dwordx4 v236, s[40:43], s62 offen lds
    ds_read_b64_tr_b16 v[144:145], v238 offset:24768
    ds_read_b64_tr_b16 v[146:147], v238 offset:25536
    ds_read_b64_tr_b16 v[148:149], v238 offset:24800
    ds_read_b64_tr_b16 v[150:151], v238 offset:25568
    s_waitcnt vmcnt(10)
    s_mov_b64 exec, 1
    ds_add_u32 v242, v243
    s_mov_b64 exec, -1
    s_waitcnt lgkmcnt(7)
    v_mfma_f32_32x32x16_bf16 v[0:15], v[128:131], v[120:123], v[0:15]
    v_mfma_f32_32x32x16_bf16 v[16:31], v[132:135], v[120:123], v[16:31]
    v_mfma_f32_32x32x16_bf16 v[32:47], v[136:139], v[120:123], v[32:47]
    ds_read_b64_tr_b16 v[152:153], v238 offset:27712
    ds_read_b64_tr_b16 v[154:155], v238 offset:28480
    s_add_u32 s63, s96, 29696
    buffer_load_dwordx4 v[116:119], v255, s[28:31], s63 offen sc1
    ds_read_b64_tr_b16 v[156:157], v238 offset:27744
    ds_read_b64_tr_b16 v[158:159], v238 offset:28512
    ds_read_b64_tr_b16 v[160:161], v238 offset:27776
    ds_read_b64_tr_b16 v[162:163], v238 offset:28544
    s_waitcnt lgkmcnt(7)
    v_mfma_f32_32x32x16_bf16 v[48:63], v[140:143], v[120:123], v[48:63]
    v_mfma_f32_32x32x16_bf16 v[64:79], v[144:147], v[120:123], v[64:79]
    s_cbranch_vccz fk_no6_22
    v_mfma_f32_32x32x16_bf16 v[80:95], v[148:151], v[120:123], v[80:95]
fk_no6_22:
    ds_read_b64_tr_b16 v[164:165], v238 offset:27808
    ds_read_b64_tr_b16 v[166:167], v238 offset:28576
    ds_read_b32 v244, v242
    ds_read_b64_tr_b16 v[168:169], v238 offset:27840
    ds_read_b64_tr_b16 v[170:171], v238 offset:28608
    ds_read_b64_tr_b16 v[172:173], v238 offset:27872
    ds_read_b64_tr_b16 v[174:175], v238 offset:28640
    s_waitcnt lgkmcnt(7)
    v_mfma_f32_32x32x16_bf16 v[0:15], v[152:155], v[124:127], v[0:15]
    v_mfma_f32_32x32x16_bf16 v[16:31], v[156:159], v[124:127], v[16:31]
    v_mfma_f32_32x32x16_bf16 v[32:47], v[160:163], v[124:127], v[32:47]
    s_setprio 2
    s_waitcnt lgkmcnt(4)
fk_sbr_35:
    v_readfirstlane_b32 s98, v244
    s_cmp_ge_u32 s98, 60
    s_cbranch_scc1 fk_sbk_36
    ds_read_b32 v244, v242
    s_waitcnt lgkmcnt(0)
    s_branch fk_sbr_35
fk_sbk_36:
    s_setprio 0
    ds_read_b64_tr_b16 v[128:129], v237 offset:0
    ds_read_b64_tr_b16 v[130:131], v237 offset:768
    s_add_u32 s63, s96, 30720
    buffer_load_dwordx4 v[120:123], v255, s[28:31], s63 offen sc1
    ds_read_b64_tr_b16 v[132:133], v237 offset:32
    ds_read_b64_tr_b16 v[134:135], v237 offset:800
    s_add_u32 m0, s97, 36960
    s_add_u32 s62, s95, 1320960
    buffer_load_dwordx4 v234, s[40:43], s62 offen lds
    ds_read_b64_tr_b16 v[136:137], v237 offset:64
    ds_read_b64_tr_b16 v[138:139], v237 offset:832
    s_add_u32 m0, s97, 37984
    s_add_u32 s62, s95, 1320960
    buffer_load_dwordx4 v235, s[40:43], s62 offen lds
    s_waitcnt lgkmcnt(6)
    v_mfma_f32_32x32x16_bf16 v[48:63], v[164:167], v[124:127], v[48:63]
    v_mfma_f32_32x32x16_bf16 v[64:79], v[168:171], v[124:127], v[64:79]
    s_cbranch_vccz fk_no6_23
    v_mfma_f32_32x32x16_bf16 v[80:95], v[172:175], v[124:127], v[80:95]
fk_no6_23:
    ds_read_b64_tr_b16 v[140:141], v237 offset:96
    ds_read_b64_tr_b16 v[142:143], v237 offset:864
    s_add_u32 m0, s97, 39008
    s_add_u32 s62, s95, 1320960
    buffer_load_dwordx4 v236, s[40:43], s62 offen lds
    ds_read_b64_tr_b16 v[144:145], v237 offset:128
    ds_read_b64_tr_b16 v[146:147], v237 offset:896
    ds_read_b64_tr_b16 v[148:149], v237 offset:160
    ds_read_b64_tr_b16 v[150:151], v237 offset:928
    s_waitcnt vmcnt(10)
    s_mov_b64 exec, 1
    ds_add_u32 v242, v243
    s_mov_b64 exec, -1
    s_waitcnt lgkmcnt(7)
    v_mfma_f32_32x32x16_bf16 v[0:15], v[128:131], v[96:99], v[0:15]
    v_mfma_f32_32x32x16_bf16 v[16:31], v[132:135], v[96:99], v[16:31]
    v_mfma_f32_32x32x16_bf16 v[32:47], v[136:139], v[96:99], v[32:47]
    ds_read_b64_tr_b16 v[152:153], v237 offset:3072
    ds_read_b64_tr_b16 v[154:155], v237 offset:3840
    s_add_u32 s63, s96, 31744
    buffer_load_dwordx4 v[124:127], v255, s[28:31], s63 offen sc1
    ds_read_b64_tr_b16 v[156:157], v237 offset:3104
    ds_read_b64_tr_b16 v[158:159], v237 offset:3872
    ds_read_b64_tr_b16 v[160:161], v237 offset:3136
    ds_read_b64_tr_b16 v[162:163], v237 offset:3904
    s_waitcnt lgkmcnt(7)
    v_mfma_f32_32x32x16_bf16 v[48:63], v[140:143], v[96:99], v[48:63]
    v_mfma_f32_32x32x16_bf16 v[64:79], v[144:147], v[96:99], v[64:79]
    s_cbranch_vccz fk_no6_24
    v_mfma_f32_32x32x16_bf16 v[80:95], v[148:151], v[96:99], v[80:95]
fk_no6_24:
    ds_read_b64_tr_b16 v[164:165], v237 offset:3168
    ds_read_b64_tr_b16 v[166:167], v237 offset:3936
    ds_read_b32 v244, v242
    ds_read_b64_tr_b16 v[168:169], v237 offset:3200
    ds_read_b64_tr_b16 v[170:171], v237 offset:3968
    ds_read_b64_tr_b16 v[172:173], v237 offset:3232
    ds_read_b64_tr_b16 v[174:175], v237 offset:4000
    s_waitcnt lgkmcnt(7)
    v_mfma_f32_32x32x16_bf16 v[0:15], v[152:155], v[100:103], v[0:15]
    v_mfma_f32_32x32x16_bf16 v[16:31], v[156:159], v[100:103], v[16:31]
    v_mfma_f32_32x32x16_bf16 v[32:47], v[160:163], v[100:103], v[32:47]
    s_setprio 2
    s_waitcnt lgkmcnt(4)
fk_sbr_37:
    v_readfirstlane_b32 s98, v244
    s_cmp_ge_u32 s98, 64
    s_cbranch_scc1 fk_sbk_38
    ds_read_b32 v244, v242
    s_waitcnt lgkmcnt(0)
    s_branch fk_sbr_37
fk_sbk_38:
    s_setprio 0
    ds_read_b64_tr_b16 v[128:129], v237 offset:12320
    ds_read_b64_tr_b16 v[130:131], v237 offset:13088
    ds_read_b64_tr_b16 v[132:133], v237 offset:12352
    ds_read_b64_tr_b16 v[134:135], v237 offset:13120
    ds_read_b64_tr_b16 v[136:137], v237 offset:12384
    ds_read_b64_tr_b16 v[138:139], v237 offset:13152
    s_lshl_b32 s3, s60, 2
    s_add_u32 s3, s3, s92
    s_mul_i32 s62, s3, 11008
    s_add_u32 s63, s62, 2816
    buffer_load_dword v228, v231, s[44:47], s62 offen
    buffer_load_dword v229, v231, s[44:47], s63 offen
    s_lshl_b32 s63, s3, 12
    buffer_load_dword v230, v233, s[48:51], s63 offen
    s_waitcnt lgkmcnt(6)
    v_mfma_f32_32x32x16_bf16 v[48:63], v[164:167], v[100:103], v[48:63]
    v_mfma_f32_32x32x16_bf16 v[64:79], v[168:171], v[100:103], v[64:79]
    s_cbranch_vccz fk_no6_25
    v_mfma_f32_32x32x16_bf16 v[80:95], v[172:175], v[100:103], v[80:95]
fk_no6_25:
    ds_read_b64_tr_b16 v[140:141], v237 offset:12416
    ds_read_b64_tr_b16 v[142:143], v237 offset:13184
    ds_read_b64_tr_b16 v[144:145], v237 offset:12448
    ds_read_b64_tr_b16 v[146:147], v237 offset:13216
    ds_read_b64_tr_b16 v[148:149], v237 offset:12480
    ds_read_b64_tr_b16 v[150:151], v237 offset:13248
    s_waitcnt vmcnt(9)
    s_mov_b64 exec, 1
    ds_add_u32 v242, v243
    s_mov_b64 exec, -1
    s_waitcnt lgkmcnt(7)
    v_mfma_f32_32x32x16_bf16 v[0:15], v[128:131], v[104:107], v[0:15]
    v_mfma_f32_32x32x16_bf16 v[16:31], v[132:135], v[104:107], v[16:31]
    v_mfma_f32_32x32x16_bf16 v[32:47], v[136:139], v[104:107], v[32:47]
    ds_read_b64_tr_b16 v[152:153], v237 offset:15392
    ds_read_b64_tr_b16 v[154:155], v237 offset:16160
    ds_read_b64_tr_b16 v[156:157], v237 offset:15424
    ds_read_b64_tr_b16 v[158:159], v237 offset:16192
    ds_read_b64_tr_b16 v[160:161], v237 offset:15456
    ds_read_b64_tr_b16 v[162:163], v237 offset:16224
    s_waitcnt lgkmcnt(7)
    v_mfma_f32_32x32x16_bf16 v[48:63], v[140:143], v[104:107], v[48:63]
    v_mfma_f32_32x32x16_bf16 v[64:79], v[144:147], v[104:107], v[64:79]
    s_cbranch_vccz fk_no6_26
    v_mfma_f32_32x32x16_bf16 v[80:95], v[148:151], v[104:107], v[80:95]
fk_no6_26:
    ds_read_b64_tr_b16 v[164:165], v237 offset:15488
    ds_read_b64_tr_b16 v[166:167], v237 offset:16256
    ds_read_b32 v244, v242
    ds_read_b64_tr_b16 v[168:169], v237 offset:15520
    ds_read_b64_tr_b16 v[170:171], v237 offset:16288
    ds_read_b64_tr_b16 v[172:173], v237 offset:15552
    ds_read_b64_tr_b16 v[174:175], v237 offset:16320
    s_waitcnt lgkmcnt(7)
    v_mfma_f32_32x32x16_bf16 v[0:15], v[152:155], v[108:111], v[0:15]
    v_mfma_f32_32x32x16_bf16 v[16:31], v[156:159], v[108:111], v[16:31]
    v_mfma_f32_32x32x16_bf16 v[32:47], v[160:163], v[108:111], v[32:47]
    s_setprio 2
    s_waitcnt lgkmcnt(4)
fk_sbr_39:
    v_readfirstlane_b32 s98, v244
    s_cmp_ge_u32 s98, 68
    s_cbranch_scc1 fk_sbk_40
    ds_read_b32 v244, v242
    s_waitcnt lgkmcnt(0)
    s_branch fk_sbr_39
fk_sbk_40:
    s_setprio 0
    ds_read_b64_tr_b16 v[128:129], v237 offset:24640
    ds_read_b64_tr_b16 v[130:131], v237 offset:25408
    ds_read_b64_tr_b16 v[132:133], v237 offset:24672
    ds_read_b64_tr_b16 v[134:135], v237 offset:25440
    ds_read_b64_tr_b16 v[136:137], v237 offset:24704
    ds_read_b64_tr_b16 v[138:139], v237 offset:25472
    s_waitcnt lgkmcnt(6)
    v_mfma_f32_32x32x16_bf16 v[48:63], v[164:167], v[108:111], v[48:63]
    v_mfma_f32_32x32x16_bf16 v[64:79], v[168:171], v[108:111], v[64:79]
    s_cbranch_vccz fk_no6_27
    v_mfma_f32_32x32x16_bf16 v[80:95], v[172:175], v[108:111], v[80:95]
fk_no6_27:
    ds_read_b64_tr_b16 v[140:141], v237 offset:24736
    ds_read_b64_tr_b16 v[142:143], v237 offset:25504
    ds_read_b64_tr_b16 v[144:145], v237 offset:24768
    ds_read_b64_tr_b16 v[146:147], v237 offset:25536
    ds_read_b64_tr_b16 v[148:149], v237 offset:24800
    ds_read_b64_tr_b16 v[150:151], v237 offset:25568
    s_waitcnt vmcnt(4)
    s_mov_b64 exec, 1
    ds_add_u32 v242, v243
    s_mov_b64 exec, -1
    s_waitcnt lgkmcnt(7)
    v_mfma_f32_32x32x16_bf16 v[0:15], v[128:131], v[112:115], v[0:15]
    v_mfma_f32_32x32x16_bf16 v[16:31], v[132:135], v[112:115], v[16:31]
    v_mfma_f32_32x32x16_bf16 v[32:47], v[136:139], v[112:115], v[32:47]
    ds_read_b64_tr_b16 v[152:153], v237 offset:27712
    ds_read_b64_tr_b16 v[154:155], v237 offset:28480
    ds_read_b64_tr_b16 v[156:157], v237 offset:27744
    ds_read_b64_tr_b16 v[158:159], v237 offset:28512
    ds_read_b64_tr_b16 v[160:161], v237 offset:27776
    ds_read_b64_tr_b16 v[162:163], v237 offset:28544
    s_waitcnt lgkmcnt(7)
    v_mfma_f32_32x32x16_bf16 v[48:63], v[140:143], v[112:115], v[48:63]
    v_mfma_f32_32x32x16_bf16 v[64:79], v[144:147], v[112:115], v[64:79]
    s_cbranch_vccz fk_no6_28
    v_mfma_f32_32x32x16_bf16 v[80:95], v[148:151], v[112:115], v[80:95]
fk_no6_28:
    ds_read_b64_tr_b16 v[164:165], v237 offset:27808
    ds_read_b64_tr_b16 v[166:167], v237 offset:28576
    ds_read_b32 v244, v242
    ds_read_b64_tr_b16 v[168:169], v237 offset:27840
    ds_read_b64_tr_b16 v[170:171], v237 offset:28608
    ds_read_b64_tr_b16 v[172:173], v237 offset:27872
    ds_read_b64_tr_b16 v[174:175], v237 offset:28640
    s_waitcnt lgkmcnt(7)
    v_mfma_f32_32x32x16_bf16 v[0:15], v[152:155], v[116:119], v[0:15]
    v_mfma_f32_32x32x16_bf16 v[16:31], v[156:159], v[116:119], v[16:31]
    v_mfma_f32_32x32x16_bf16 v[32:47], v[160:163], v[116:119], v[32:47]
    s_setprio 2
    s_waitcnt lgkmcnt(4)
fk_sbr_41:
    v_readfirstlane_b32 s98, v244
    s_cmp_ge_u32 s98, 72
    s_cbranch_scc1 fk_sbk_42
    ds_read_b32 v244, v242
    s_waitcnt lgkmcnt(0)
    s_branch fk_sbr_41
fk_sbk_42:
    s_setprio 0
    ds_read_b64_tr_b16 v[128:129], v238 offset:0
    ds_read_b64_tr_b16 v[130:131], v238 offset:768
    ds_read_b64_tr_b16 v[132:133], v238 offset:32
    ds_read_b64_tr_b16 v[134:135], v238 offset:800
    ds_read_b64_tr_b16 v[136:137], v238 offset:64
    ds_read_b64_tr_b16 v[138:139], v238 offset:832
    s_waitcnt lgkmcnt(6)
    v_mfma_f32_32x32x16_bf16 v[48:63], v[164:167], v[116:119], v[48:63]
    v_mfma_f32_32x32x16_bf16 v[64:79], v[168:171], v[116:119], v[64:79]
    s_cbranch_vccz fk_no6_29
    v_mfma_f32_32x32x16_bf16 v[80:95], v[172:175], v[116:119], v[80:95]
fk_no6_29:
    ds_read_b64_tr_b16 v[140:141], v238 offset:96
    ds_read_b64_tr_b16 v[142:143], v238 offset:864
    ds_read_b64_tr_b16 v[144:145], v238 offset:128
    ds_read_b64_tr_b16 v[146:147], v238 offset:896
    ds_read_b64_tr_b16 v[148:149], v238 offset:160
    ds_read_b64_tr_b16 v[150:151], v238 offset:928
    s_waitcnt lgkmcnt(6)
    v_mfma_f32_32x32x16_bf16 v[0:15], v[128:131], v[120:123], v[0:15]
    v_mfma_f32_32x32x16_bf16 v[16:31], v[132:135], v[120:123], v[16:31]
    v_mfma_f32_32x32x16_bf16 v[32:47], v[136:139], v[120:123], v[32:47]
    ds_read_b64_tr_b16 v[152:153], v238 offset:3072
    ds_read_b64_tr_b16 v[154:155], v238 offset:3840
    ds_read_b64_tr_b16 v[156:157], v238 offset:3104
    ds_read_b64_tr_b16 v[158:159], v238 offset:3872
    ds_read_b64_tr_b16 v[160:161], v238 offset:3136
    ds_read_b64_tr_b16 v[162:163], v238 offset:3904
    s_waitcnt lgkmcnt(6)
    v_mfma_f32_32x32x16_bf16 v[48:63], v[140:143], v[120:123], v[48:63]
    v_mfma_f32_32x32x16_bf16 v[64:79], v[144:147], v[120:123], v[64:79]
    s_cbranch_vccz fk_no6_30
    v_mfma_f32_32x32x16_bf16 v[80:95], v[148:151], v[120:123], v[80:95]
fk_no6_30:
    ds_read_b64_tr_b16 v[164:165], v238 offset:3168
    ds_read_b64_tr_b16 v[166:167], v238 offset:3936
    ds_read_b64_tr_b16 v[168:169], v238 offset:3200
    ds_read_b64_tr_b16 v[170:171], v238 offset:3968
    ds_read_b64_tr_b16 v[172:173], v238 offset:3232
    ds_read_b64_tr_b16 v[174:175], v238 offset:4000
    s_waitcnt vmcnt(3)
    s_waitcnt lgkmcnt(6)
    v_mfma_f32_32x32x16_bf16 v[0:15], v[152:155], v[124:127], v[0:15]
    v_mfma_f32_32x32x16_bf16 v[16:31], v[156:159], v[124:127], v[16:31]
    v_mfma_f32_32x32x16_bf16 v[32:47], v[160:163], v[124:127], v[32:47]
    s_waitcnt lgkmcnt(0)
    v_mfma_f32_32x32x16_bf16 v[48:63], v[164:167], v[124:127], v[48:63]
    v_mfma_f32_32x32x16_bf16 v[64:79], v[168:171], v[124:127], v[64:79]
    s_cbranch_vccz fk_no6_31
    v_mfma_f32_32x32x16_bf16 v[80:95], v[172:175], v[124:127], v[80:95]
fk_no6_31:
    s_mov_b64 exec, 1
    ds_add_u32 v242, v243
    s_mov_b64 exec, -1
    s_waitcnt lgkmcnt(0)
    s_setprio 2
    s_mul_i32 s100, s93, 86
    s_add_u32 s100, s100, s94
    s_lshl_b32 s100, s100, 10
    s_add_u32 s100, s100, 5242880
    s_lshl_b32 s94, s93, 13
    s_lshl_b32 s63, s101, 6
    s_add_u32 s94, s94, s63
    s_add_u32 s94, s94, 262144
    s_nop 1
    v_pk_mul_f32 v[176:177], v[0:1], v[0:1]
    v_pk_mul_f32 v[178:179], v[2:3], v[2:3]
    v_pk_mul_f32 v[180:181], v[4:5], v[4:5]
    v_pk_mul_f32 v[182:183], v[6:7], v[6:7]
    v_pk_fma_f32 v[176:177], v[176:177], v[248:249], v[246:247]
    v_pk_fma_f32 v[178:179], v[178:179], v[248:249], v[246:247]
    v_pk_fma_f32 v[180:181], v[180:181], v[248:249], v[246:247]
    v_pk_fma_f32 v[182:183], v[182:183], v[248:249], v[246:247]
    v_pk_mul_f32 v[176:177], v[176:177], v[0:1]
    v_pk_mul_f32 v[178:179], v[178:179], v[2:3]
    v_pk_mul_f32 v[180:181], v[180:181], v[4:5]
    v_pk_mul_f32 v[182:183], v[182:183], v[6:7]
    v_exp_f32 v176, v176
    v_exp_f32 v177, v177
    v_exp_f32 v178, v178
    v_exp_f32 v179, v179
    v_exp_f32 v180, v180
    v_exp_f32 v181, v181
    v_exp_f32 v182, v182
    v_exp_f32 v183, v183
    v_pk_mul_f32 v[0:1], v[0:1], v[8:9]
    v_pk_mul_f32 v[2:3], v[2:3], v[10:11]
    v_pk_mul_f32 v[4:5], v[4:5], v[12:13]
    v_pk_mul_f32 v[6:7], v[6:7], v[14:15]
    v_pk_add_f32 v[176:177], v[176:177], v[250:251]
    v_pk_add_f32 v[178:179], v[178:179], v[250:251]
    v_pk_add_f32 v[180:181], v[180:181], v[250:251]
    v_pk_add_f32 v[182:183], v[182:183], v[250:251]
    v_rcp_f32 v176, v176
    v_rcp_f32 v177, v177
    v_rcp_f32 v178, v178
    v_rcp_f32 v179, v179
    v_rcp_f32 v180, v180
    v_rcp_f32 v181, v181
    v_rcp_f32 v182, v182
    v_rcp_f32 v183, v183
    s_nop 0
    v_pk_mul_f32 v[0:1], v[0:1], v[176:177]
    v_pk_mul_f32 v[2:3], v[2:3], v[178:179]
    v_pk_mul_f32 v[4:5], v[4:5], v[180:181]
    v_pk_mul_f32 v[6:7], v[6:7], v[182:183]
    v_cvt_pk_bf16_f32 v184, v0, v1
    v_cvt_pk_bf16_f32 v185, v2, v3
    v_cvt_pk_bf16_f32 v186, v4, v5
    v_cvt_pk_bf16_f32 v187, v6, v7
    buffer_store_dwordx4 v[184:187], v255, s[28:31], s100 offen offset:0 sc1
    v_pk_mul_f32 v[176:177], v[16:17], v[16:17]
    v_pk_mul_f32 v[178:179], v[18:19], v[18:19]
    v_pk_mul_f32 v[180:181], v[20:21], v[20:21]
    v_pk_mul_f32 v[182:183], v[22:23], v[22:23]
    v_pk_fma_f32 v[176:177], v[176:177], v[248:249], v[246:247]
    v_pk_fma_f32 v[178:179], v[178:179], v[248:249], v[246:247]
    v_pk_fma_f32 v[180:181], v[180:181], v[248:249], v[246:247]
    v_pk_fma_f32 v[182:183], v[182:183], v[248:249], v[246:247]
    v_pk_mul_f32 v[176:177], v[176:177], v[16:17]
    v_pk_mul_f32 v[178:179], v[178:179], v[18:19]
    v_pk_mul_f32 v[180:181], v[180:181], v[20:21]
    v_pk_mul_f32 v[182:183], v[182:183], v[22:23]
    v_exp_f32 v176, v176
    v_exp_f32 v177, v177
    v_exp_f32 v178, v178
    v_exp_f32 v179, v179
    v_exp_f32 v180, v180
    v_exp_f32 v181, v181
    v_exp_f32 v182, v182
    v_exp_f32 v183, v183
    v_pk_mul_f32 v[16:17], v[16:17], v[24:25]
    v_pk_mul_f32 v[18:19], v[18:19], v[26:27]
    v_pk_mul_f32 v[20:21], v[20:21], v[28:29]
    v_pk_mul_f32 v[22:23], v[22:23], v[30:31]
    v_pk_add_f32 v[176:177], v[176:177], v[250:251]
    v_pk_add_f32 v[178:179], v[178:179], v[250:251]
    v_pk_add_f32 v[180:181], v[180:181], v[250:251]
    v_pk_add_f32 v[182:183], v[182:183], v[250:251]
    v_rcp_f32 v176, v176
    v_rcp_f32 v177, v177
    v_rcp_f32 v178, v178
    v_rcp_f32 v179, v179
    v_rcp_f32 v180, v180
    v_rcp_f32 v181, v181
    v_rcp_f32 v182, v182
    v_rcp_f32 v183, v183
    s_nop 0
    v_pk_mul_f32 v[16:17], v[16:17], v[176:177]
    v_pk_mul_f32 v[18:19], v[18:19], v[178:179]
    v_pk_mul_f32 v[20:21], v[20:21], v[180:181]
    v_pk_mul_f32 v[22:23], v[22:23], v[182:183]
    v_cvt_pk_bf16_f32 v184, v16, v17
    v_cvt_pk_bf16_f32 v185, v18, v19
    v_cvt_pk_bf16_f32 v186, v20, v21
    v_cvt_pk_bf16_f32 v187, v22, v23
    buffer_store_dwordx4 v[184:187], v255, s[28:31], s100 offen offset:1024 sc1
    v_pk_mul_f32 v[176:177], v[32:33], v[32:33]
    v_pk_mul_f32 v[178:179], v[34:35], v[34:35]
    v_pk_mul_f32 v[180:181], v[36:37], v[36:37]
    v_pk_mul_f32 v[182:183], v[38:39], v[38:39]
    v_pk_fma_f32 v[176:177], v[176:177], v[248:249], v[246:247]
    v_pk_fma_f32 v[178:179], v[178:179], v[248:249], v[246:247]
    v_pk_fma_f32 v[180:181], v[180:181], v[248:249], v[246:247]
    v_pk_fma_f32 v[182:183], v[182:183], v[248:249], v[246:247]
    v_pk_mul_f32 v[176:177], v[176:177], v[32:33]
    v_pk_mul_f32 v[178:179], v[178:179], v[34:35]
    v_pk_mul_f32 v[180:181], v[180:181], v[36:37]
    v_pk_mul_f32 v[182:183], v[182:183], v[38:39]
    v_exp_f32 v176, v176
    v_exp_f32 v177, v177
    v_exp_f32 v178, v178
    v_exp_f32 v179, v179
    v_exp_f32 v180, v180
    v_exp_f32 v181, v181
    v_exp_f32 v182, v182
    v_exp_f32 v183, v183
    v_pk_mul_f32 v[32:33], v[32:33], v[40:41]
    v_pk_mul_f32 v[34:35], v[34:35], v[42:43]
    v_pk_mul_f32 v[36:37], v[36:37], v[44:45]
    v_pk_mul_f32 v[38:39], v[38:39], v[46:47]
    v_pk_add_f32 v[176:177], v[176:177], v[250:251]
    v_pk_add_f32 v[178:179], v[178:179], v[250:251]
    v_pk_add_f32 v[180:181], v[180:181], v[250:251]
    v_pk_add_f32 v[182:183], v[182:183], v[250:251]
    v_rcp_f32 v176, v176
    v_rcp_f32 v177, v177
    v_rcp_f32 v178, v178
    v_rcp_f32 v179, v179
    v_rcp_f32 v180, v180
    v_rcp_f32 v181, v181
    v_rcp_f32 v182, v182
    v_rcp_f32 v183, v183
    s_nop 0
    v_pk_mul_f32 v[32:33], v[32:33], v[176:177]
    v_pk_mul_f32 v[34:35], v[34:35], v[178:179]
    v_pk_mul_f32 v[36:37], v[36:37], v[180:181]
    v_pk_mul_f32 v[38:39], v[38:39], v[182:183]
    v_cvt_pk_bf16_f32 v184, v32, v33
    v_cvt_pk_bf16_f32 v185, v34, v35
    v_cvt_pk_bf16_f32 v186, v36, v37
    v_cvt_pk_bf16_f32 v187, v38, v39
    buffer_store_dwordx4 v[184:187], v255, s[28:31], s100 offen offset:2048 sc1
    ds_read_b32 v244, v242
    s_mul_i32 s99, s92, 22
    s_cmp_eq_u32 s92, 3
    s_cselect_b32 s62, 1, 0
    s_mov_b32 s18, 0x10730820
    s_cselect_b32 s18, 0xe628820, s18
    s_mov_b32 s19, 0x2518358b
    s_cselect_b32 s19, 0x2518358b, s19
    s_mov_b32 s20, 0x1ca49483
    s_cselect_b32 s20, 0x1ca4a083, s20
    s_mov_b32 s21, 0x526f
    s_cselect_b32 s21, 0x526f, s21
    s_sub_u32 s99, s99, s62
    s_cmp_lt_u32 s92, 2
    s_cselect_b32 s18, 0x10730820, s18
    s_cselect_b32 s19, 0x2728b9ac, s19
    s_cselect_b32 s20, 0x16a49483, s20
    s_cselect_b32 s21, 0xad20f, s21
    s_and_b32 s15, s57, 62
    s_lshl_b32 s14, s15, 13
    s_and_b32 s62, s92, 1
    s_add_u32 s15, s15, s62
    s_xor_b32 s62, s15, 0
    s_mul_i32 s62, s62, 86
    s_add_u32 s62, s62, s99
    s_lshl_b32 s62, s62, 10
    s_add_u32 s96, s62, 5242880
    s_xor_b32 s62, s15, 1
    s_mul_i32 s62, s62, 86
    s_add_u32 s62, s62, s99
    s_lshl_b32 s62, s62, 10
    s_add_u32 s5, s62, 5242880
    s_and_b32 s62, s57, 1
    s_lshl_b32 s62, s62, 2
    s_add_u32 s62, s62, s58
    s_lshl_b32 s101, s62, 7
    s_lshl_b32 s95, s99, 14
    s_add_u32 s95, s95, s101
    s_lshl_b32 s4, s92, 17
    s_add_u32 s4, s4, s101
    s_lshl_b32 s62, s92, 8
    s_add_u32 s14, s14, s62
    s_add_u32 s14, s14, 262144
    s_mul_i32 s97, s92, 18432
    s_add_u32 s97, s97, 73728
    v_mov_b32 v234, v226
    v_mov_b32 v235, v227
    s_waitcnt vmcnt(0)
    s_mov_b64 exec, 1
    buffer_store_dword v232, v233, s[28:31], s94 offen sc1
    s_mov_b64 exec, -1
    s_add_u32 s94, s94, 1024
    s_waitcnt lgkmcnt(0)
fk_sbr_43:
    v_readfirstlane_b32 s98, v244
    s_cmp_ge_u32 s98, 76
    s_cbranch_scc1 fk_sbk_44
    ds_read_b32 v244, v242
    s_waitcnt lgkmcnt(0)
    s_branch fk_sbr_43
fk_sbk_44:
    v_pk_mul_f32 v[176:177], v[48:49], v[48:49]
    v_pk_mul_f32 v[178:179], v[50:51], v[50:51]
    v_pk_mul_f32 v[180:181], v[52:53], v[52:53]
    v_pk_mul_f32 v[182:183], v[54:55], v[54:55]
    v_pk_fma_f32 v[176:177], v[176:177], v[248:249], v[246:247]
    v_pk_fma_f32 v[178:179], v[178:179], v[248:249], v[246:247]
    v_pk_fma_f32 v[180:181], v[180:181], v[248:249], v[246:247]
    v_pk_fma_f32 v[182:183], v[182:183], v[248:249], v[246:247]
    v_pk_mul_f32 v[176:177], v[176:177], v[48:49]
    v_pk_mul_f32 v[178:179], v[178:179], v[50:51]
    v_pk_mul_f32 v[180:181], v[180:181], v[52:53]
    v_pk_mul_f32 v[182:183], v[182:183], v[54:55]
    s_bfe_u32 s6, s18, 0x50000
    s_lshl_b32 s6, s6, 14
    s_add_u32 s6, s6, s95
    s_add_u32 m0, s97, 0
    s_add_u32 s62, s6, 0
    buffer_load_dwordx4 v234, s[44:47], s62 offen lds
    s_add_u32 m0, s97, 1024
    s_add_u32 s62, s6, 8192
    buffer_load_dwordx4 v234, s[44:47], s62 offen lds
    v_exp_f32 v176, v176
    v_exp_f32 v177, v177
    v_exp_f32 v178, v178
    v_exp_f32 v179, v179
    v_exp_f32 v180, v180
    v_exp_f32 v181, v181
    v_exp_f32 v182, v182
    v_exp_f32 v183, v183
    s_bfe_u32 s6, s18, 0x50005
    s_lshl_b32 s6, s6, 14
    s_add_u32 s6, s6, s95
    s_add_u32 m0, s97, 2048
    s_add_u32 s62, s6, 0
    buffer_load_dwordx4 v234, s[44:47], s62 offen lds
    s_add_u32 m0, s97, 3072
    s_add_u32 s62, s6, 8192
    buffer_load_dwordx4 v234, s[44:47], s62 offen lds
    v_pk_mul_f32 v[48:49], v[48:49], v[56:57]
    v_pk_mul_f32 v[50:51], v[50:51], v[58:59]
    v_pk_mul_f32 v[52:53], v[52:53], v[60:61]
    v_pk_mul_f32 v[54:55], v[54:55], v[62:63]
    v_pk_add_f32 v[176:177], v[176:177], v[250:251]
    v_pk_add_f32 v[178:179], v[178:179], v[250:251]
    v_pk_add_f32 v[180:181], v[180:181], v[250:251]
    v_pk_add_f32 v[182:183], v[182:183], v[250:251]
    s_bfe_u32 s6, s18, 0x5000a
    s_lshl_b32 s6, s6, 14
    s_add_u32 s6, s6, s95
    s_add_u32 m0, s97, 4096
    s_add_u32 s62, s6, 0
    buffer_load_dwordx4 v234, s[44:47], s62 offen lds
    s_add_u32 m0, s97, 5120
    s_add_u32 s62, s6, 8192
    buffer_load_dwordx4 v234, s[44:47], s62 offen lds
    v_rcp_f32 v176, v176
    v_rcp_f32 v177, v177
    v_rcp_f32 v178, v178
    v_rcp_f32 v179, v179
    v_rcp_f32 v180, v180
    v_rcp_f32 v181, v181
    v_rcp_f32 v182, v182
    v_rcp_f32 v183, v183
    s_bfe_u32 s6, s18, 0x5000f
    s_lshl_b32 s6, s6, 14
    s_add_u32 s6, s6, s95
    s_add_u32 m0, s97, 6144
    s_add_u32 s62, s6, 0
    buffer_load_dwordx4 v234, s[44:47], s62 offen lds
    s_add_u32 m0, s97, 7168
    s_add_u32 s62, s6, 8192
    buffer_load_dwordx4 v234, s[44:47], s62 offen lds
    s_nop 0
    v_pk_mul_f32 v[48:49], v[48:49], v[176:177]
    v_pk_mul_f32 v[50:51], v[50:51], v[178:179]
    v_pk_mul_f32 v[52:53], v[52:53], v[180:181]
    v_pk_mul_f32 v[54:55], v[54:55], v[182:183]
    v_cvt_pk_bf16_f32 v184, v48, v49
    v_cvt_pk_bf16_f32 v185, v50, v51
    v_cvt_pk_bf16_f32 v186, v52, v53
    v_cvt_pk_bf16_f32 v187, v54, v55
    s_add_u32 s100, s100, 3072
    buffer_store_dwordx4 v[184:187], v255, s[28:31], s100 offen offset:0 sc1
    v_pk_mul_f32 v[176:177], v[64:65], v[64:65]
    v_pk_mul_f32 v[178:179], v[66:67], v[66:67]
    v_pk_mul_f32 v[180:181], v[68:69], v[68:69]
    v_pk_mul_f32 v[182:183], v[70:71], v[70:71]
    v_pk_fma_f32 v[176:177], v[176:177], v[248:249], v[246:247]
    v_pk_fma_f32 v[178:179], v[178:179], v[248:249], v[246:247]
    v_pk_fma_f32 v[180:181], v[180:181], v[248:249], v[246:247]
    v_pk_fma_f32 v[182:183], v[182:183], v[248:249], v[246:247]
    v_pk_mul_f32 v[176:177], v[176:177], v[64:65]
    v_pk_mul_f32 v[178:179], v[178:179], v[66:67]
    v_pk_mul_f32 v[180:181], v[180:181], v[68:69]
    v_pk_mul_f32 v[182:183], v[182:183], v[70:71]
    s_bfe_u32 s6, s18, 0x50014
    s_lshl_b32 s6, s6, 14
    s_add_u32 s6, s6, s95
    s_add_u32 m0, s97, 8192
    s_add_u32 s62, s6, 0
    buffer_load_dwordx4 v234, s[44:47], s62 offen lds
    s_add_u32 m0, s97, 9216
    s_add_u32 s62, s6, 8192
    buffer_load_dwordx4 v234, s[44:47], s62 offen lds
    v_exp_f32 v176, v176
    v_exp_f32 v177, v177
    v_exp_f32 v178, v178
    v_exp_f32 v179, v179
    v_exp_f32 v180, v180
    v_exp_f32 v181, v181
    v_exp_f32 v182, v182
    v_exp_f32 v183, v183
    s_bfe_u32 s6, s18, 0x50019
    s_lshl_b32 s6, s6, 14
    s_add_u32 s6, s6, s95
    s_add_u32 m0, s97, 10240
    s_add_u32 s62, s6, 0
    buffer_load_dwordx4 v234, s[44:47], s62 offen lds
    s_add_u32 m0, s97, 11264
    s_add_u32 s62, s6, 8192
    buffer_load_dwordx4 v234, s[44:47], s62 offen lds
    v_pk_mul_f32 v[64:65], v[64:65], v[72:73]
    v_pk_mul_f32 v[66:67], v[66:67], v[74:75]
    v_pk_mul_f32 v[68:69], v[68:69], v[76:77]
    v_pk_mul_f32 v[70:71], v[70:71], v[78:79]
    v_pk_add_f32 v[176:177], v[176:177], v[250:251]
    v_pk_add_f32 v[178:179], v[178:179], v[250:251]
    v_pk_add_f32 v[180:181], v[180:181], v[250:251]
    v_pk_add_f32 v[182:183], v[182:183], v[250:251]
    s_bfe_u32 s6, s19, 0x50000
    s_lshl_b32 s6, s6, 14
    s_add_u32 s6, s6, s95
    s_add_u32 m0, s97, 12288
    s_add_u32 s62, s6, 0
    buffer_load_dwordx4 v234, s[44:47], s62 offen lds
    s_add_u32 m0, s97, 13312
    s_add_u32 s62, s6, 8192
    buffer_load_dwordx4 v234, s[44:47], s62 offen lds
    v_rcp_f32 v176, v176
    v_rcp_f32 v177, v177
    v_rcp_f32 v178, v178
    v_rcp_f32 v179, v179
    v_rcp_f32 v180, v180
    v_rcp_f32 v181, v181
    v_rcp_f32 v182, v182
    v_rcp_f32 v183, v183
    s_bfe_u32 s6, s19, 0x50005
    s_lshl_b32 s6, s6, 14
    s_add_u32 s6, s6, s95
    s_add_u32 m0, s97, 14336
    s_add_u32 s62, s6, 0
    buffer_load_dwordx4 v234, s[44:47], s62 offen lds
    s_add_u32 m0, s97, 15360
    s_add_u32 s62, s6, 8192
    buffer_load_dwordx4 v234, s[44:47], s62 offen lds
    s_nop 0
    v_pk_mul_f32 v[64:65], v[64:65], v[176:177]
    v_pk_mul_f32 v[66:67], v[66:67], v[178:179]
    v_pk_mul_f32 v[68:69], v[68:69], v[180:181]
    v_pk_mul_f32 v[70:71], v[70:71], v[182:183]
    v_cvt_pk_bf16_f32 v184, v64, v65
    v_cvt_pk_bf16_f32 v185, v66, v67
    v_cvt_pk_bf16_f32 v186, v68, v69
    v_cvt_pk_bf16_f32 v187, v70, v71
    buffer_store_dwordx4 v[184:187], v255, s[28:31], s100 offen offset:1024 sc1
    s_mov_b64 exec, 0xff
    buffer_load_dword v236, v235, s[28:31], s14 offen offset:0 sc1
    s_mov_b64 exec, -1
    s_cmp_eq_u32 s22, 1
    s_cbranch_scc1 fk_gu_six
    s_waitcnt vmcnt(0)
    s_branch fk_gu_done
fk_gu_six:
    v_pk_mul_f32 v[176:177], v[80:81], v[80:81]
    v_pk_mul_f32 v[178:179], v[82:83], v[82:83]
    v_pk_mul_f32 v[180:181], v[84:85], v[84:85]
    v_pk_mul_f32 v[182:183], v[86:87], v[86:87]
    v_pk_fma_f32 v[176:177], v[176:177], v[248:249], v[246:247]
    v_pk_fma_f32 v[178:179], v[178:179], v[248:249], v[246:247]
    v_pk_fma_f32 v[180:181], v[180:181], v[248:249], v[246:247]
    v_pk_fma_f32 v[182:183], v[182:183], v[248:249], v[246:247]
    v_pk_mul_f32 v[176:177], v[176:177], v[80:81]
    v_pk_mul_f32 v[178:179], v[178:179], v[82:83]
    v_pk_mul_f32 v[180:181], v[180:181], v[84:85]
    v_pk_mul_f32 v[182:183], v[182:183], v[86:87]
    v_exp_f32 v176, v176
    v_exp_f32 v177, v177
    v_exp_f32 v178, v178
    v_exp_f32 v179, v179
    v_exp_f32 v180, v180
    v_exp_f32 v181, v181
    v_exp_f32 v182, v182
    v_exp_f32 v183, v183
    v_pk_mul_f32 v[80:81], v[80:81], v[88:89]
    v_pk_mul_f32 v[82:83], v[82:83], v[90:91]
    v_pk_mul_f32 v[84:85], v[84:85], v[92:93]
    v_pk_mul_f32 v[86:87], v[86:87], v[94:95]
    v_pk_add_f32 v[176:177], v[176:177], v[250:251]
    v_pk_add_f32 v[178:179], v[178:179], v[250:251]
    v_pk_add_f32 v[180:181], v[180:181], v[250:251]
    v_pk_add_f32 v[182:183], v[182:183], v[250:251]
    v_rcp_f32 v176, v176
    v_rcp_f32 v177, v177
    v_rcp_f32 v178, v178
    v_rcp_f32 v179, v179
    v_rcp_f32 v180, v180
    v_rcp_f32 v181, v181
    v_rcp_f32 v182, v182
    v_rcp_f32 v183, v183
    s_nop 0
    v_pk_mul_f32 v[80:81], v[80:81], v[176:177]
    v_pk_mul_f32 v[82:83], v[82:83], v[178:179]
    v_pk_mul_f32 v[84:85], v[84:85], v[180:181]
    v_pk_mul_f32 v[86:87], v[86:87], v[182:183]
    v_cvt_pk_bf16_f32 v184, v80, v81
    v_cvt_pk_bf16_f32 v185, v82, v83
    v_cvt_pk_bf16_f32 v186, v84, v85
    v_cvt_pk_bf16_f32 v187, v86, v87
    buffer_store_dwordx4 v[184:187], v255, s[28:31], s100 offen offset:2048 sc1
    s_waitcnt vmcnt(1)
fk_gu_done:
    s_mov_b64 exec, 0xff
    v_cmp_eq_u32 vcc, s61, v236
    s_mov_b64 exec, -1
    s_cmp_eq_u64 vcc, 0xff
    s_cbranch_scc1 fk_fok_45
    s_add_u32 s63, s14, 0
    s_mov_b32 s3, 0
fk_poll_46:
    s_mov_b64 exec, 0xff
    buffer_load_dword v236, v235, s[28:31], s63 offen sc1
    s_waitcnt vmcnt(0)
    v_cmp_eq_u32 vcc, s61, v236
    s_mov_b64 exec, -1
    s_cmp_eq_u64 vcc, 0xff
    s_cbranch_scc1 fk_pollok_47
    s_sleep 2
    s_add_u32 s3, s3, 1
    s_cmp_lt_u32 s3, 32768
    s_cbranch_scc1 fk_poll_46
fk_pollok_47:
fk_fok_45:
    s_bfe_u32 s3, s18, 0x50000
    s_lshl_b32 s3, s3, 10
    s_add_u32 s63, s3, s96
    buffer_load_dwordx4 v[128:131], v255, s[28:31], s63 offen sc1
    s_add_u32 s63, s3, s5
    buffer_load_dwordx4 v[132:135], v255, s[28:31], s63 offen sc1
    s_bfe_u32 s3, s18, 0x50005
    s_lshl_b32 s3, s3, 10
    s_add_u32 s63, s3, s96
    buffer_load_dwordx4 v[136:139], v255, s[28:31], s63 offen sc1
    s_add_u32 s63, s3, s5
    buffer_load_dwordx4 v[140:143], v255, s[28:31], s63 offen sc1
    s_bfe_u32 s3, s18, 0x5000a
    s_lshl_b32 s3, s3, 10
    s_add_u32 s63, s3, s96
    buffer_load_dwordx4 v[144:147], v255, s[28:31], s63 offen sc1
    s_add_u32 s63, s3, s5
    buffer_load_dwordx4 v[148:151], v255, s[28:31], s63 offen sc1
    s_bfe_u32 s3, s18, 0x5000f
    s_lshl_b32 s3, s3, 10
    s_add_u32 s63, s3, s96
    buffer_load_dwordx4 v[152:155], v255, s[28:31], s63 offen sc1
    s_add_u32 s63, s3, s5
    buffer_load_dwordx4 v[156:159], v255, s[28:31], s63 offen sc1
    s_bfe_u32 s3, s18, 0x50014
    s_lshl_b32 s3, s3, 10
    s_add_u32 s63, s3, s96
    buffer_load_dwordx4 v[160:163], v255, s[28:31], s63 offen sc1
    s_add_u32 s63, s3, s5
    buffer_load_dwordx4 v[164:167], v255, s[28:31], s63 offen sc1
    s_bfe_u32 s3, s18, 0x50019
    s_lshl_b32 s3, s3, 10
    s_add_u32 s63, s3, s96
    buffer_load_dwordx4 v[168:171], v255, s[28:31], s63 offen sc1
    s_add_u32 s63, s3, s5
    buffer_load_dwordx4 v[172:175], v255, s[28:31], s63 offen sc1
    s_bfe_u32 s3, s19, 0x50000
    s_lshl_b32 s3, s3, 10
    s_add_u32 s63, s3, s96
    buffer_load_dwordx4 v[176:179], v255, s[28:31], s63 offen sc1
    s_add_u32 s63, s3, s5
    buffer_load_dwordx4 v[180:183], v255, s[28:31], s63 offen sc1
    s_bfe_u32 s3, s19, 0x50005
    s_lshl_b32 s3, s3, 10
    s_add_u32 s63, s3, s96
    buffer_load_dwordx4 v[184:187], v255, s[28:31], s63 offen sc1
    s_add_u32 s63, s3, s5
    buffer_load_dwordx4 v[188:191], v255, s[28:31], s63 offen sc1
    s_bfe_u32 s3, s19, 0x5000a
    s_lshl_b32 s3, s3, 10
    s_add_u32 s63, s3, s96
    buffer_load_dwordx4 v[192:195], v255, s[28:31], s63 offen sc1
    s_add_u32 s63, s3, s5
    buffer_load_dwordx4 v[196:199], v255, s[28:31], s63 offen sc1
    s_bfe_u32 s3, s19, 0x5000f
    s_lshl_b32 s3, s3, 10
    s_add_u32 s63, s3, s96
    buffer_load_dwordx4 v[200:203], v255, s[28:31], s63 offen sc1
    s_add_u32 s63, s3, s5
    buffer_load_dwordx4 v[204:207], v255, s[28:31], s63 offen sc1
    s_bfe_u32 s3, s19, 0x50014
    s_lshl_b32 s3, s3, 10
    s_add_u32 s63, s3, s96
    buffer_load_dwordx4 v[208:211], v255, s[28:31], s63 offen sc1
    s_add_u32 s63, s3, s5
    buffer_load_dwordx4 v[212:215], v255, s[28:31], s63 offen sc1
    s_bfe_u32 s3, s19, 0x50019
    s_lshl_b32 s3, s3, 10
    s_add_u32 s63, s3, s96
    buffer_load_dwordx4 v[216:219], v255, s[28:31], s63 offen sc1
    s_add_u32 s63, s3, s5
    buffer_load_dwordx4 v[220:223], v255, s[28:31], s63 offen sc1
    s_waitcnt vmcnt(24)
    s_mov_b64 exec, 1
    buffer_store_dword v232, v233, s[28:31], s94 offen sc1
    s_mov_b64 exec, -1
    s_lshl_b32 s62, s57, 2
    s_add_u32 s62, s62, s58
    s_lshl_b32 s62, s62, 3
    s_add_u32 s62, s62, s92
    s_lshl_b32 s62, s62, 10
    s_add_u32 s62, s62, 3149824
    v_mov_b32 v96, -1
    v_mov_b32 v97, -1
    v_mov_b32 v98, -1
    v_mov_b32 v99, -1
    buffer_store_dwordx4 v[96:99], v255, s[28:31], s62 offen sc1
    s_mov_b32 s7, s92
    s_call_b64 s[8:9], fk_finalize
    s_mul_i32 s99, s92, 9216
    s_setprio 0
    ds_read_b64_tr_b16 v[64:65], v224 offset:0
    ds_read_b64_tr_b16 v[66:67], v224 offset:1024
    ds_read_b64_tr_b16 v[68:69], v225 offset:0
    ds_read_b64_tr_b16 v[70:71], v225 offset:1024
    s_waitcnt vmcnt(25)
    s_waitcnt lgkmcnt(2)
    v_mfma_f32_32x32x16_bf16 v[0:15], v[64:67], v[128:131], 0
    v_mfma_f32_32x32x16_bf16 v[16:31], v[64:67], v[132:135], 0
    ds_read_b64_tr_b16 v[72:73], v224 offset:2048
    ds_read_b64_tr_b16 v[74:75], v224 offset:3072
    s_bfe_u32 s6, s19, 0x5000a
    s_lshl_b32 s6, s6, 14
    s_add_u32 s6, s6, s95
    s_add_u32 m0, s97, 16384
    s_add_u32 s62, s6, 0
    buffer_load_dwordx4 v234, s[44:47], s62 offen lds
    s_waitcnt lgkmcnt(2)
    v_mfma_f32_32x32x16_bf16 v[32:47], v[68:71], v[128:131], 0
    v_mfma_f32_32x32x16_bf16 v[48:63], v[68:71], v[132:135], 0
    ds_read_b64_tr_b16 v[76:77], v225 offset:2048
    ds_read_b64_tr_b16 v[78:79], v225 offset:3072
    s_add_u32 m0, s97, 17408
    s_add_u32 s62, s6, 8192
    buffer_load_dwordx4 v234, s[44:47], s62 offen lds
    s_add_u32 m0, s99, 0
    s_add_u32 s62, s4, 0
    buffer_load_dwordx4 v234, s[48:51], s62 offen lds
    s_add_u32 m0, s99, 1024
    s_add_u32 s62, s4, 8192
    buffer_load_dwordx4 v234, s[48:51], s62 offen lds
    s_waitcnt vmcnt(27)
    s_waitcnt lgkmcnt(2)
    v_mfma_f32_32x32x16_bf16 v[0:15], v[72:75], v[136:139], v[0:15]
    v_mfma_f32_32x32x16_bf16 v[16:31], v[72:75], v[140:143], v[16:31]
    ds_read_b64_tr_b16 v[64:65], v224 offset:4096
    ds_read_b64_tr_b16 v[66:67], v224 offset:5120
    s_bfe_u32 s6, s19, 0x5000f
    s_lshl_b32 s6, s6, 14
    s_add_u32 s6, s6, s95
    s_add_u32 m0, s97, 0
    s_add_u32 s62, s6, 0
    buffer_load_dwordx4 v234, s[44:47], s62 offen lds
    s_waitcnt lgkmcnt(2)
    v_mfma_f32_32x32x16_bf16 v[32:47], v[76:79], v[136:139], v[32:47]
    v_mfma_f32_32x32x16_bf16 v[48:63], v[76:79], v[140:143], v[48:63]
    ds_read_b64_tr_b16 v[68:69], v225 offset:4096
    ds_read_b64_tr_b16 v[70:71], v225 offset:5120
    s_add_u32 m0, s97, 1024
    s_add_u32 s62, s6, 8192
    buffer_load_dwordx4 v234, s[44:47], s62 offen lds
    s_add_u32 m0, s99, 2048
    s_add_u32 s62, s4, 16384
    buffer_load_dwordx4 v234, s[48:51], s62 offen lds
    s_add_u32 m0, s99, 3072
    s_add_u32 s62, s4, 24576
    buffer_load_dwordx4 v234, s[48:51], s62 offen lds
    s_waitcnt vmcnt(29)
    s_waitcnt lgkmcnt(2)
    v_mfma_f32_32x32x16_bf16 v[0:15], v[64:67], v[144:147], v[0:15]
    v_mfma_f32_32x32x16_bf16 v[16:31], v[64:67], v[148:151], v[16:31]
    ds_read_b64_tr_b16 v[72:73], v224 offset:6144
    ds_read_b64_tr_b16 v[74:75], v224 offset:7168
    s_bfe_u32 s6, s19, 0x50014
    s_lshl_b32 s6, s6, 14
    s_add_u32 s6, s6, s95
    s_add_u32 m0, s97, 2048
    s_add_u32 s62, s6, 0
    buffer_load_dwordx4 v234, s[44:47], s62 offen lds
    s_waitcnt lgkmcnt(2)
    v_mfma_f32_32x32x16_bf16 v[32:47], v[68:71], v[144:147], v[32:47]
    v_mfma_f32_32x32x16_bf16 v[48:63], v[68:71], v[148:151], v[48:63]
    ds_read_b64_tr_b16 v[76:77], v225 offset:6144
    ds_read_b64_tr_b16 v[78:79], v225 offset:7168
    s_add_u32 m0, s97, 3072
    s_add_u32 s62, s6, 8192
    buffer_load_dwordx4 v234, s[44:47], s62 offen lds
    s_waitcnt vmcnt(10)
    s_mov_b64 exec, 1
    buffer_store_dword v232, v233, s[28:31], s10 offen sc1
    s_mov_b64 exec, -1
    s_add_u32 m0, s99, 4096
    s_add_u32 s62, s4, 32768
    buffer_load_dwordx4 v234, s[48:51], s62 offen lds
    s_add_u32 m0, s99, 5120
    s_add_u32 s62, s4, 40960
    buffer_load_dwordx4 v234, s[48:51], s62 offen lds
    s_waitcnt lgkmcnt(2)
    v_mfma_f32_32x32x16_bf16 v[0:15], v[72:75], v[152:155], v[0:15]
    v_mfma_f32_32x32x16_bf16 v[16:31], v[72:75], v[156:159], v[16:31]
    ds_read_b64_tr_b16 v[64:65], v224 offset:8192
    ds_read_b64_tr_b16 v[66:67], v224 offset:9216
    s_bfe_u32 s6, s19, 0x50019
    s_lshl_b32 s6, s6, 14
    s_add_u32 s6, s6, s95
    s_add_u32 m0, s97, 4096
    s_add_u32 s62, s6, 0
    buffer_load_dwordx4 v234, s[44:47], s62 offen lds
    s_waitcnt lgkmcnt(2)
    v_mfma_f32_32x32x16_bf16 v[32:47], v[76:79], v[152:155], v[32:47]
    v_mfma_f32_32x32x16_bf16 v[48:63], v[76:79], v[156:159], v[48:63]
    ds_read_b64_tr_b16 v[68:69], v225 offset:8192
    ds_read_b64_tr_b16 v[70:71], v225 offset:9216
    s_add_u32 m0, s97, 5120
    s_add_u32 s62, s6, 8192
    buffer_load_dwordx4 v234, s[44:47], s62 offen lds
    s_add_u32 m0, s99, 6144
    s_add_u32 s62, s4, 49152
    buffer_load_dwordx4 v234, s[48:51], s62 offen lds
    s_add_u32 m0, s99, 7168
    s_add_u32 s62, s4, 57344
    buffer_load_dwordx4 v234, s[48:51], s62 offen lds
    s_waitcnt lgkmcnt(2)
    v_mfma_f32_32x32x16_bf16 v[0:15], v[64:67], v[160:163], v[0:15]
    v_mfma_f32_32x32x16_bf16 v[16:31], v[64:67], v[164:167], v[16:31]
    ds_read_b64_tr_b16 v[72:73], v224 offset:10240
    ds_read_b64_tr_b16 v[74:75], v224 offset:11264
    s_bfe_u32 s6, s20, 0x50000
    s_lshl_b32 s6, s6, 14
    s_add_u32 s6, s6, s95
    s_add_u32 m0, s97, 6144
    s_add_u32 s62, s6, 0
    buffer_load_dwordx4 v234, s[44:47], s62 offen lds
    s_waitcnt lgkmcnt(2)
    v_mfma_f32_32x32x16_bf16 v[32:47], v[68:71], v[160:163], v[32:47]
    v_mfma_f32_32x32x16_bf16 v[48:63], v[68:71], v[164:167], v[48:63]
    ds_read_b64_tr_b16 v[76:77], v225 offset:10240
    ds_read_b64_tr_b16 v[78:79], v225 offset:11264
    s_add_u32 m0, s97, 7168
    s_add_u32 s62, s6, 8192
    buffer_load_dwordx4 v234, s[44:47], s62 offen lds
    s_waitcnt lgkmcnt(2)
    v_mfma_f32_32x32x16_bf16 v[0:15], v[72:75], v[168:171], v[0:15]
    v_mfma_f32_32x32x16_bf16 v[16:31], v[72:75], v[172:175], v[16:31]
    ds_read_b64_tr_b16 v[64:65], v224 offset:12288
    ds_read_b64_tr_b16 v[66:67], v224 offset:13312
    s_bfe_u32 s6, s20, 0x50005
    s_lshl_b32 s6, s6, 14
    s_add_u32 s6, s6, s95
    s_add_u32 m0, s97, 8192
    s_add_u32 s62, s6, 0
    buffer_load_dwordx4 v234, s[44:47], s62 offen lds
    s_waitcnt lgkmcnt(2)
    v_mfma_f32_32x32x16_bf16 v[32:47], v[76:79], v[168:171], v[32:47]
    v_mfma_f32_32x32x16_bf16 v[48:63], v[76:79], v[172:175], v[48:63]
    ds_read_b64_tr_b16 v[68:69], v225 offset:12288
    ds_read_b64_tr_b16 v[70:71], v225 offset:13312
    s_add_u32 m0, s97, 9216
    s_add_u32 s62, s6, 8192
    buffer_load_dwordx4 v234, s[44:47], s62 offen lds
    s_mov_b64 exec, 0xff
    buffer_load_dword v236, v235, s[28:31], s14 offen offset:1024 sc1
    s_mov_b64 exec, -1
    s_waitcnt lgkmcnt(2)
    v_mfma_f32_32x32x16_bf16 v[0:15], v[64:67], v[176:179], v[0:15]
    v_mfma_f32_32x32x16_bf16 v[16:31], v[64:67], v[180:183], v[16:31]
    ds_read_b64_tr_b16 v[72:73], v224 offset:14336
    ds_read_b64_tr_b16 v[74:75], v224 offset:15360
    s_bfe_u32 s6, s20, 0x5000a
    s_lshl_b32 s6, s6, 14
    s_add_u32 s6, s6, s95
    s_add_u32 m0, s97, 10240
    s_add_u32 s62, s6, 0
    buffer_load_dwordx4 v234, s[44:47], s62 offen lds
    s_waitcnt lgkmcnt(2)
    v_mfma_f32_32x32x16_bf16 v[32:47], v[68:71], v[176:179], v[32:47]
    v_mfma_f32_32x32x16_bf16 v[48:63], v[68:71], v[180:183], v[48:63]
    ds_read_b64_tr_b16 v[76:77], v225 offset:14336
    ds_read_b64_tr_b16 v[78:79], v225 offset:15360
    s_add_u32 m0, s97, 11264
    s_add_u32 s62, s6, 8192
    buffer_load_dwordx4 v234, s[44:47], s62 offen lds
    s_waitcnt lgkmcnt(2)
    v_mfma_f32_32x32x16_bf16 v[0:15], v[72:75], v[184:187], v[0:15]
    v_mfma_f32_32x32x16_bf16 v[16:31], v[72:75], v[188:191], v[16:31]
    s_waitcnt vmcnt(22)
    ds_read_b64_tr_b16 v[64:65], v224 offset:16384
    ds_read_b64_tr_b16 v[66:67], v224 offset:17408
    s_bfe_u32 s6, s20, 0x5000f
    s_lshl_b32 s6, s6, 14
    s_add_u32 s6, s6, s95
    s_add_u32 m0, s97, 12288
    s_add_u32 s62, s6, 0
    buffer_load_dwordx4 v234, s[44:47], s62 offen lds
    s_waitcnt lgkmcnt(2)
    v_mfma_f32_32x32x16_bf16 v[32:47], v[76:79], v[184:187], v[32:47]
    v_mfma_f32_32x32x16_bf16 v[48:63], v[76:79], v[188:191], v[48:63]
    ds_read_b64_tr_b16 v[68:69], v225 offset:16384
    ds_read_b64_tr_b16 v[70:71], v225 offset:17408
    s_add_u32 m0, s97, 13312
    s_add_u32 s62, s6, 8192
    buffer_load_dwordx4 v234, s[44:47], s62 offen lds
    s_setprio 2
    s_waitcnt vmcnt(4)
    s_mov_b64 exec, 0xff
    v_cmp_eq_u32 vcc, s61, v236
    s_mov_b64 exec, -1
    s_cmp_eq_u64 vcc, 0xff
    s_cbranch_scc1 fk_fok_48
    s_add_u32 s63, s14, 1024
    s_mov_b32 s3, 0
fk_poll_49:
    s_mov_b64 exec, 0xff
    buffer_load_dword v236, v235, s[28:31], s63 offen sc1
    s_waitcnt vmcnt(0)
    v_cmp_eq_u32 vcc, s61, v236
    s_mov_b64 exec, -1
    s_cmp_eq_u64 vcc, 0xff
    s_cbranch_scc1 fk_pollok_50
    s_sleep 2
    s_add_u32 s3, s3, 1
    s_cmp_lt_u32 s3, 32768
    s_cbranch_scc1 fk_poll_49
fk_pollok_50:
fk_fok_48:
    s_setprio 0
    s_bfe_u32 s3, s20, 0x50000
    s_lshl_b32 s3, s3, 10
    s_add_u32 s63, s3, s96
    buffer_load_dwordx4 v[80:83], v255, s[28:31], s63 offen sc1
    s_add_u32 s63, s3, s5
    buffer_load_dwordx4 v[84:87], v255, s[28:31], s63 offen sc1
    s_bfe_u32 s3, s20, 0x50005
    s_lshl_b32 s3, s3, 10
    s_add_u32 s63, s3, s96
    buffer_load_dwordx4 v[88:91], v255, s[28:31], s63 offen sc1
    s_add_u32 s63, s3, s5
    buffer_load_dwordx4 v[92:95], v255, s[28:31], s63 offen sc1
    s_waitcnt lgkmcnt(2)
    v_mfma_f32_32x32x16_bf16 v[0:15], v[64:67], v[192:195], v[0:15]
    v_mfma_f32_32x32x16_bf16 v[16:31], v[64:67], v[196:199], v[16:31]
    ds_read_b64_tr_b16 v[72:73], v224 offset:0
    ds_read_b64_tr_b16 v[74:75], v224 offset:1024
    s_bfe_u32 s6, s20, 0x50014
    s_lshl_b32 s6, s6, 14
    s_add_u32 s6, s6, s95
    s_add_u32 m0, s97, 14336
    s_add_u32 s62, s6, 0
    buffer_load_dwordx4 v234, s[44:47], s62 offen lds
    s_waitcnt lgkmcnt(2)
    v_mfma_f32_32x32x16_bf16 v[32:47], v[68:71], v[192:195], v[32:47]
    v_mfma_f32_32x32x16_bf16 v[48:63], v[68:71], v[196:199], v[48:63]
    ds_read_b64_tr_b16 v[76:77], v225 offset:0
    ds_read_b64_tr_b16 v[78:79], v225 offset:1024
    s_add_u32 m0, s97, 15360
    s_add_u32 s62, s6, 8192
    buffer_load_dwordx4 v234, s[44:47], s62 offen lds
    s_lshl_b32 s62, s92, 8
    s_add_u32 s94, s14, s62
    s_mov_b64 exec, 0xff
    buffer_load_dword v236, v235, s[28:31], s94 offen offset:2048 sc1
    s_mov_b64 exec, -1
    s_bfe_u32 s3, s20, 0x5000a
    s_lshl_b32 s3, s3, 10
    s_add_u32 s63, s3, s96
    buffer_load_dwordx4 v[96:99], v255, s[28:31], s63 offen sc1
    s_add_u32 s63, s3, s5
    buffer_load_dwordx4 v[100:103], v255, s[28:31], s63 offen sc1
    s_bfe_u32 s3, s20, 0x5000f
    s_lshl_b32 s3, s3, 10
    s_add_u32 s63, s3, s96
    buffer_load_dwordx4 v[104:107], v255, s[28:31], s63 offen sc1
    s_add_u32 s63, s3, s5
    buffer_load_dwordx4 v[108:111], v255, s[28:31], s63 offen sc1
    s_waitcnt lgkmcnt(2)
    v_mfma_f32_32x32x16_bf16 v[0:15], v[72:75], v[200:203], v[0:15]
    v_mfma_f32_32x32x16_bf16 v[16:31], v[72:75], v[204:207], v[16:31]
    ds_read_b64_tr_b16 v[64:65], v224 offset:2048
    ds_read_b64_tr_b16 v[66:67], v224 offset:3072
    s_bfe_u32 s6, s20, 0x50019
    s_lshl_b32 s6, s6, 14
    s_add_u32 s6, s6, s95
    s_add_u32 m0, s97, 16384
    s_add_u32 s62, s6, 0
    buffer_load_dwordx4 v234, s[44:47], s62 offen lds
    s_waitcnt lgkmcnt(2)
    v_mfma_f32_32x32x16_bf16 v[32:47], v[76:79], v[200:203], v[32:47]
    v_mfma_f32_32x32x16_bf16 v[48:63], v[76:79], v[204:207], v[48:63]
    ds_read_b64_tr_b16 v[68:69], v225 offset:2048
    ds_read_b64_tr_b16 v[70:71], v225 offset:3072
    s_add_u32 m0, s97, 17408
    s_add_u32 s62, s6, 8192
    buffer_load_dwordx4 v234, s[44:47], s62 offen lds
    s_bfe_u32 s3, s20, 0x50014
    s_lshl_b32 s3, s3, 10
    s_add_u32 s63, s3, s96
    buffer_load_dwordx4 v[112:115], v255, s[28:31], s63 offen sc1
    s_add_u32 s63, s3, s5
    buffer_load_dwordx4 v[116:119], v255, s[28:31], s63 offen sc1
    s_bfe_u32 s3, s20, 0x50019
    s_lshl_b32 s3, s3, 10
    s_add_u32 s63, s3, s96
    buffer_load_dwordx4 v[120:123], v255, s[28:31], s63 offen sc1
    s_add_u32 s63, s3, s5
    buffer_load_dwordx4 v[124:127], v255, s[28:31], s63 offen sc1
    s_waitcnt lgkmcnt(2)
    v_mfma_f32_32x32x16_bf16 v[0:15], v[64:67], v[208:211], v[0:15]
    v_mfma_f32_32x32x16_bf16 v[16:31], v[64:67], v[212:215], v[16:31]
    ds_read_b64_tr_b16 v[72:73], v224 offset:4096
    ds_read_b64_tr_b16 v[74:75], v224 offset:5120
    s_bfe_u32 s6, s21, 0x50000
    s_lshl_b32 s6, s6, 14
    s_add_u32 s6, s6, s95
    s_add_u32 m0, s97, 0
    s_add_u32 s62, s6, 0
    buffer_load_dwordx4 v234, s[44:47], s62 offen lds
    s_waitcnt lgkmcnt(2)
    v_mfma_f32_32x32x16_bf16 v[32:47], v[68:71], v[208:211], v[32:47]
    v_mfma_f32_32x32x16_bf16 v[48:63], v[68:71], v[212:215], v[48:63]
    ds_read_b64_tr_b16 v[76:77], v225 offset:4096
    ds_read_b64_tr_b16 v[78:79], v225 offset:5120
    s_add_u32 m0, s97, 1024
    s_add_u32 s62, s6, 8192
    buffer_load_dwordx4 v234, s[44:47], s62 offen lds
    s_setprio 2
    s_waitcnt vmcnt(12)
    s_mov_b64 exec, 0xff
    v_cmp_eq_u32 vcc, s61, v236
    s_mov_b64 exec, -1
    s_cmp_eq_u64 vcc, 0xff
    s_cbranch_scc1 fk_fok_51
    s_add_u32 s63, s94, 2048
    s_mov_b32 s3, 0
fk_poll_52:
    s_mov_b64 exec, 0xff
    buffer_load_dword v236, v235, s[28:31], s63 offen sc1
    s_waitcnt vmcnt(0)
    v_cmp_eq_u32 vcc, s61, v236
    s_mov_b64 exec, -1
    s_cmp_eq_u64 vcc, 0xff
    s_cbranch_scc1 fk_pollok_53
    s_sleep 2
    s_add_u32 s3, s3, 1
    s_cmp_lt_u32 s3, 32768
    s_cbranch_scc1 fk_poll_52
fk_pollok_53:
fk_fok_51:
    s_setprio 0
    s_mov_b64 exec, 1
    ds_add_u32 v242, v243 offset:8
    s_mov_b64 exec, -1
    s_bfe_u32 s3, s21, 0x50000
    s_lshl_b32 s3, s3, 10
    s_add_u32 s63, s3, s96
    buffer_load_dwordx4 v[128:131], v255, s[28:31], s63 offen sc1
    s_add_u32 s63, s3, s5
    buffer_load_dwordx4 v[132:135], v255, s[28:31], s63 offen sc1
    s_bfe_u32 s3, s21, 0x50005
    s_lshl_b32 s3, s3, 10
    s_add_u32 s63, s3, s96
    buffer_load_dwordx4 v[136:139], v255, s[28:31], s63 offen sc1
    s_add_u32 s63, s3, s5
    buffer_load_dwordx4 v[140:143], v255, s[28:31], s63 offen sc1
    s_waitcnt lgkmcnt(3)
    v_mfma_f32_32x32x16_bf16 v[0:15], v[72:75], v[216:219], v[0:15]
    v_mfma_f32_32x32x16_bf16 v[16:31], v[72:75], v[220:223], v[16:31]
    ds_read_b64_tr_b16 v[64:65], v224 offset:6144
    ds_read_b64_tr_b16 v[66:67], v224 offset:7168
    s_bfe_u32 s6, s21, 0x50005
    s_lshl_b32 s6, s6, 14
    s_add_u32 s6, s6, s95
    s_add_u32 m0, s97, 2048
    s_add_u32 s62, s6, 0
    buffer_load_dwordx4 v234, s[44:47], s62 offen lds
    s_waitcnt lgkmcnt(3)
    v_mfma_f32_32x32x16_bf16 v[32:47], v[76:79], v[216:219], v[32:47]
    v_mfma_f32_32x32x16_bf16 v[48:63], v[76:79], v[220:223], v[48:63]
    ds_read_b64_tr_b16 v[68:69], v225 offset:6144
    ds_read_b64_tr_b16 v[70:71], v225 offset:7168
    s_add_u32 m0, s97, 3072
    s_add_u32 s62, s6, 8192
    buffer_load_dwordx4 v234, s[44:47], s62 offen lds
    s_cmp_eq_u32 s56, 7
    s_cselect_b32 s62, s2, 0
    s_cmp_lg_u32 s62, 255
    s_cbranch_scc1 fk_noepoch11
    s_setprio 2
    s_mov_b32 s63, 266240
    v_lshlrev_b32 v239, 13, v254
    buffer_load_dword v228, v239, s[28:31], s63 offen offset:0 sc1
    buffer_load_dword v229, v239, s[28:31], s63 offen offset:64 sc1
    buffer_load_dword v230, v239, s[28:31], s63 offen offset:128 sc1
    buffer_load_dword v231, v239, s[28:31], s63 offen offset:192 sc1
    s_setprio 0
fk_noepoch11:
    s_bfe_u32 s3, s21, 0x5000a
    s_lshl_b32 s3, s3, 10
    s_add_u32 s63, s3, s96
    buffer_load_dwordx4 v[144:147], v255, s[28:31], s63 offen sc1
    s_add_u32 s63, s3, s5
    buffer_load_dwordx4 v[148:151], v255, s[28:31], s63 offen sc1
    s_cmp_ge_u32 s92, 2
    s_cselect_b32 s96, 0x70000000, s96
    s_cselect_b32 s5, 0x70000000, s5
    s_bfe_u32 s3, s21, 0x5000f
    s_lshl_b32 s3, s3, 10
    s_add_u32 s63, s3, s96
    buffer_load_dwordx4 v[152:155], v255, s[28:31], s63 offen sc1
    s_add_u32 s63, s3, s5
    buffer_load_dwordx4 v[156:159], v255, s[28:31], s63 offen sc1
    s_waitcnt lgkmcnt(2)
    v_mfma_f32_32x32x16_bf16 v[0:15], v[64:67], v[80:83], v[0:15]
    v_mfma_f32_32x32x16_bf16 v[16:31], v[64:67], v[84:87], v[16:31]
    ds_read_b64_tr_b16 v[72:73], v224 offset:8192
    ds_read_b64_tr_b16 v[74:75], v224 offset:9216
    s_bfe_u32 s6, s21, 0x5000a
    s_lshl_b32 s6, s6, 14
    s_add_u32 s6, s6, s95
    s_add_u32 m0, s97, 4096
    s_add_u32 s62, s6, 0
    buffer_load_dwordx4 v234, s[44:47], s62 offen lds
    s_waitcnt lgkmcnt(2)
    v_mfma_f32_32x32x16_bf16 v[32:47], v[68:71], v[80:83], v[32:47]
    v_mfma_f32_32x32x16_bf16 v[48:63], v[68:71], v[84:87], v[48:63]
    ds_read_b64_tr_b16 v[76:77], v225 offset:8192
    ds_read_b64_tr_b16 v[78:79], v225 offset:9216
    s_add_u32 m0, s97, 5120
    s_add_u32 s62, s6, 8192
    buffer_load_dwordx4 v234, s[44:47], s62 offen lds
    s_waitcnt lgkmcnt(2)
    v_mfma_f32_32x32x16_bf16 v[0:15], v[72:75], v[88:91], v[0:15]
    v_mfma_f32_32x32x16_bf16 v[16:31], v[72:75], v[92:95], v[16:31]
    ds_read_b64_tr_b16 v[64:65], v224 offset:10240
    ds_read_b64_tr_b16 v[66:67], v224 offset:11264
    s_bfe_u32 s6, s21, 0x5000f
    s_lshl_b32 s6, s6, 14
    s_add_u32 s6, s6, s95
    s_add_u32 m0, s97, 6144
    s_add_u32 s62, s6, 0
    buffer_load_dwordx4 v234, s[44:47], s62 offen lds
    s_waitcnt lgkmcnt(2)
    v_mfma_f32_32x32x16_bf16 v[32:47], v[76:79], v[88:91], v[32:47]
    v_mfma_f32_32x32x16_bf16 v[48:63], v[76:79], v[92:95], v[48:63]
    ds_read_b64_tr_b16 v[68:69], v225 offset:10240
    ds_read_b64_tr_b16 v[70:71], v225 offset:11264
    s_add_u32 m0, s97, 7168
    s_add_u32 s62, s6, 8192
    buffer_load_dwordx4 v234, s[44:47], s62 offen lds
    s_waitcnt vmcnt(24)
    s_waitcnt lgkmcnt(2)
    v_mfma_f32_32x32x16_bf16 v[0:15], v[64:67], v[96:99], v[0:15]
    v_mfma_f32_32x32x16_bf16 v[16:31], v[64:67], v[100:103], v[16:31]
    ds_read_b64_tr_b16 v[72:73], v224 offset:12288
    ds_read_b64_tr_b16 v[74:75], v224 offset:13312
    s_waitcnt lgkmcnt(2)
    v_mfma_f32_32x32x16_bf16 v[32:47], v[68:71], v[96:99], v[32:47]
    v_mfma_f32_32x32x16_bf16 v[48:63], v[68:71], v[100:103], v[48:63]
    ds_read_b64_tr_b16 v[76:77], v225 offset:12288
    ds_read_b64_tr_b16 v[78:79], v225 offset:13312
    s_waitcnt vmcnt(22)
    s_waitcnt lgkmcnt(2)
    v_mfma_f32_32x32x16_bf16 v[0:15], v[72:75], v[104:107], v[0:15]
    v_mfma_f32_32x32x16_bf16 v[16:31], v[72:75], v[108:111], v[16:31]
    ds_read_b64_tr_b16 v[64:65], v224 offset:14336
    ds_read_b64_tr_b16 v[66:67], v224 offset:15360
    s_waitcnt lgkmcnt(2)
    v_mfma_f32_32x32x16_bf16 v[32:47], v[76:79], v[104:107], v[32:47]
    v_mfma_f32_32x32x16_bf16 v[48:63], v[76:79], v[108:111], v[48:63]
    ds_read_b64_tr_b16 v[68:69], v225 offset:14336
    ds_read_b64_tr_b16 v[70:71], v225 offset:15360
    s_waitcnt vmcnt(18)
    s_waitcnt lgkmcnt(2)
    v_mfma_f32_32x32x16_bf16 v[0:15], v[64:67], v[112:115], v[0:15]
    v_mfma_f32_32x32x16_bf16 v[16:31], v[64:67], v[116:119], v[16:31]
    ds_read_b64_tr_b16 v[72:73], v224 offset:16384
    ds_read_b64_tr_b16 v[74:75], v224 offset:17408
    s_waitcnt lgkmcnt(2)
    v_mfma_f32_32x32x16_bf16 v[32:47], v[68:71], v[112:115], v[32:47]
    v_mfma_f32_32x32x16_bf16 v[48:63], v[68:71], v[116:119], v[48:63]
    ds_read_b64_tr_b16 v[76:77], v225 offset:16384
    ds_read_b64_tr_b16 v[78:79], v225 offset:17408
    s_waitcnt vmcnt(16)
    s_waitcnt lgkmcnt(2)
    v_mfma_f32_32x32x16_bf16 v[0:15], v[72:75], v[120:123], v[0:15]
    v_mfma_f32_32x32x16_bf16 v[16:31], v[72:75], v[124:127], v[16:31]
    s_waitcnt vmcnt(14)
    ds_read_b64_tr_b16 v[64:65], v224 offset:0
    ds_read_b64_tr_b16 v[66:67], v224 offset:1024
    s_waitcnt lgkmcnt(2)
    v_mfma_f32_32x32x16_bf16 v[32:47], v[76:79], v[120:123], v[32:47]
    v_mfma_f32_32x32x16_bf16 v[48:63], v[76:79], v[124:127], v[48:63]
    ds_read_b64_tr_b16 v[68:69], v225 offset:0
    ds_read_b64_tr_b16 v[70:71], v225 offset:1024
    s_waitcnt vmcnt(12)
    s_waitcnt lgkmcnt(2)
    v_mfma_f32_32x32x16_bf16 v[0:15], v[64:67], v[128:131], v[0:15]
    v_mfma_f32_32x32x16_bf16 v[16:31], v[64:67], v[132:135], v[16:31]
    s_waitcnt vmcnt(8)
    ds_read_b64_tr_b16 v[72:73], v224 offset:2048
    ds_read_b64_tr_b16 v[74:75], v224 offset:3072
    s_waitcnt lgkmcnt(2)
    v_mfma_f32_32x32x16_bf16 v[32:47], v[68:71], v[128:131], v[32:47]
    v_mfma_f32_32x32x16_bf16 v[48:63], v[68:71], v[132:135], v[48:63]
    ds_read_b64_tr_b16 v[76:77], v225 offset:2048
    ds_read_b64_tr_b16 v[78:79], v225 offset:3072
    s_cmp_eq_u32 s56, 7
    s_cselect_b32 s62, s2, 0
    s_cmp_lg_u32 s62, 255
    s_cbranch_scc1 fk_noepoch18
    s_setprio 2
    s_mov_b32 s63, 266240
    s_waitcnt vmcnt(0)
    v_xor_b32 v228, s61, v228
    v_xor_b32 v229, s61, v229
    v_xor_b32 v230, s61, v230
    v_xor_b32 v231, s61, v231
    v_or3_b32 v228, v228, v229, v230
    v_or_b32 v228, v228, v231
    v_cmp_eq_u32 vcc, 0, v228
    s_cmp_eq_u64 vcc, -1
    s_cbranch_scc1 fk_epoch_go
    s_mov_b32 s63, 266240
    s_mov_b32 s3, 0
fk_poll_54:
    s_mov_b64 exec, -1
    buffer_load_dword v228, v239, s[28:31], s63 offen sc1
    buffer_load_dword v229, v239, s[28:31], s63 offen offset:64 sc1
    s_waitcnt vmcnt(0)
    v_xor_b32 v228, s61, v228
    v_xor_b32 v229, s61, v229
    v_or_b32 v228, v228, v229
    v_cmp_eq_u32 vcc, 0, v228
    s_mov_b64 exec, -1
    s_cmp_eq_u64 vcc, -1
    s_cbranch_scc1 fk_pollok_55
    s_sleep 4
    s_add_u32 s3, s3, 1
    s_cmp_lt_u32 s3, 32768
    s_cbranch_scc1 fk_poll_54
fk_pollok_55:
    s_mov_b32 s63, 266368
    s_mov_b32 s3, 0
fk_poll_56:
    s_mov_b64 exec, -1
    buffer_load_dword v228, v239, s[28:31], s63 offen sc1
    buffer_load_dword v229, v239, s[28:31], s63 offen offset:64 sc1
    s_waitcnt vmcnt(0)
    v_xor_b32 v228, s61, v228
    v_xor_b32 v229, s61, v229
    v_or_b32 v228, v228, v229
    v_cmp_eq_u32 vcc, 0, v228
    s_mov_b64 exec, -1
    s_cmp_eq_u64 vcc, -1
    s_cbranch_scc1 fk_pollok_57
    s_sleep 4
    s_add_u32 s3, s3, 1
    s_cmp_lt_u32 s3, 32768
    s_cbranch_scc1 fk_poll_56
fk_pollok_57:
fk_epoch_go:
    s_mov_b32 s62, 0
    s_mov_b64 exec, 1
    buffer_store_dword v232, v233, s[28:31], s62 offen sc1
    s_mov_b64 exec, -1
    s_setprio 0
fk_noepoch18:
    s_waitcnt lgkmcnt(2)
    v_mfma_f32_32x32x16_bf16 v[0:15], v[72:75], v[136:139], v[0:15]
    v_mfma_f32_32x32x16_bf16 v[16:31], v[72:75], v[140:143], v[16:31]
    s_waitcnt vmcnt(2)
    ds_read_b64_tr_b16 v[64:65], v224 offset:4096
    ds_read_b64_tr_b16 v[66:67], v224 offset:5120
    s_waitcnt lgkmcnt(2)
    v_mfma_f32_32x32x16_bf16 v[32:47], v[76:79], v[136:139], v[32:47]
    v_mfma_f32_32x32x16_bf16 v[48:63], v[76:79], v[140:143], v[48:63]
    ds_read_b64_tr_b16 v[68:69], v225 offset:4096
    ds_read_b64_tr_b16 v[70:71], v225 offset:5120
    s_waitcnt lgkmcnt(2)
    v_mfma_f32_32x32x16_bf16 v[0:15], v[64:67], v[144:147], v[0:15]
    v_mfma_f32_32x32x16_bf16 v[16:31], v[64:67], v[148:151], v[16:31]
    s_waitcnt vmcnt(0)
    ds_read_b64_tr_b16 v[72:73], v224 offset:6144
    ds_read_b64_tr_b16 v[74:75], v224 offset:7168
    s_waitcnt lgkmcnt(2)
    v_mfma_f32_32x32x16_bf16 v[32:47], v[68:71], v[144:147], v[32:47]
    v_mfma_f32_32x32x16_bf16 v[48:63], v[68:71], v[148:151], v[48:63]
    ds_read_b64_tr_b16 v[76:77], v225 offset:6144
    ds_read_b64_tr_b16 v[78:79], v225 offset:7168
    s_waitcnt lgkmcnt(2)
    v_mfma_f32_32x32x16_bf16 v[0:15], v[72:75], v[152:155], v[0:15]
    v_mfma_f32_32x32x16_bf16 v[16:31], v[72:75], v[156:159], v[16:31]
    s_waitcnt lgkmcnt(0)
    v_mfma_f32_32x32x16_bf16 v[32:47], v[76:79], v[152:155], v[32:47]
    v_mfma_f32_32x32x16_bf16 v[48:63], v[76:79], v[156:159], v[48:63]
    s_setprio 2
    s_xor_b32 s62, s92, 1
    s_mul_i32 s62, s62, 18432
    s_add_u32 s62, s62, 73728
    v_add_u32 v229, s62, v255
    s_xor_b32 s62, s92, 2
    s_mul_i32 s62, s62, 18432
    s_add_u32 s62, s62, 77824
    v_add_u32 v230, s62, v255
    s_xor_b32 s62, s92, 3
    s_mul_i32 s62, s62, 18432
    s_add_u32 s62, s62, 81920
    v_add_u32 v231, s62, v255
    v_add_u32 v241, s97, v255
    s_waitcnt vmcnt(0) lgkmcnt(0)
    ds_write_b128 v241, v[16:19] offset:0
    ds_write_b128 v241, v[20:23] offset:1024
    ds_write_b128 v241, v[24:27] offset:2048
    ds_write_b128 v241, v[28:31] offset:3072
    ds_write_b128 v241, v[32:35] offset:4096
    ds_write_b128 v241, v[36:39] offset:5120
    ds_write_b128 v241, v[40:43] offset:6144
    ds_write_b128 v241, v[44:47] offset:7168
    ds_write_b128 v241, v[48:51] offset:8192
    ds_write_b128 v241, v[52:55] offset:9216
    ds_write_b128 v241, v[56:59] offset:10240
    ds_write_b128 v241, v[60:63] offset:11264
    s_mov_b64 exec, 1
    ds_add_u32 v242, v243
    s_mov_b64 exec, -1
    s_waitcnt lgkmcnt(0)
    ds_read_b32 v244, v242
    s_waitcnt lgkmcnt(0)
fk_sbr_58:
    v_readfirstlane_b32 s98, v244
    s_cmp_ge_u32 s98, 80
    s_cbranch_scc1 fk_sbk_59
    ds_read_b32 v244, v242
    s_waitcnt lgkmcnt(0)
    s_branch fk_sbr_58
fk_sbk_59:
    ds_read_b128 v[16:19], v229 offset:0
    ds_read_b128 v[20:23], v229 offset:1024
    ds_read_b128 v[24:27], v229 offset:2048
    ds_read_b128 v[28:31], v229 offset:3072
    ds_read_b128 v[32:35], v230 offset:0
    ds_read_b128 v[36:39], v230 offset:1024
    ds_read_b128 v[40:43], v230 offset:2048
    ds_read_b128 v[44:47], v230 offset:3072
    ds_read_b128 v[48:51], v231 offset:0
    ds_read_b128 v[52:55], v231 offset:1024
    ds_read_b128 v[56:59], v231 offset:2048
    ds_read_b128 v[60:63], v231 offset:3072
    s_waitcnt lgkmcnt(0)
    v_pk_add_f32 v[16:17], v[16:17], v[32:33]
    v_pk_add_f32 v[0:1], v[0:1], v[48:49]
    v_pk_add_f32 v[18:19], v[18:19], v[34:35]
    v_pk_add_f32 v[2:3], v[2:3], v[50:51]
    v_pk_add_f32 v[20:21], v[20:21], v[36:37]
    v_pk_add_f32 v[4:5], v[4:5], v[52:53]
    v_pk_add_f32 v[22:23], v[22:23], v[38:39]
    v_pk_add_f32 v[6:7], v[6:7], v[54:55]
    v_pk_add_f32 v[24:25], v[24:25], v[40:41]
    v_pk_add_f32 v[8:9], v[8:9], v[56:57]
    v_pk_add_f32 v[26:27], v[26:27], v[42:43]
    v_pk_add_f32 v[10:11], v[10:11], v[58:59]
    v_pk_add_f32 v[28:29], v[28:29], v[44:45]
    v_pk_add_f32 v[12:13], v[12:13], v[60:61]
    v_pk_add_f32 v[30:31], v[30:31], v[46:47]
    v_pk_add_f32 v[14:15], v[14:15], v[62:63]
    v_pk_add_f32 v[112:113], v[0:1], v[16:17]
    v_pk_add_f32 v[114:115], v[2:3], v[18:19]
    v_pk_add_f32 v[116:117], v[4:5], v[20:21]
    v_pk_add_f32 v[118:119], v[6:7], v[22:23]
    v_pk_add_f32 v[120:121], v[8:9], v[24:25]
    v_pk_add_f32 v[122:123], v[10:11], v[26:27]
    v_pk_add_f32 v[124:125], v[12:13], v[28:29]
    v_pk_add_f32 v[126:127], v[14:15], v[30:31]
    s_mov_b32 s63, 0xbfb8aa3b
    v_mul_f32 v64, s63, v112
    v_mul_f32 v65, s63, v113
    v_mul_f32 v66, s63, v114
    v_mul_f32 v67, s63, v115
    v_mul_f32 v68, s63, v116
    v_mul_f32 v69, s63, v117
    v_mul_f32 v70, s63, v118
    v_mul_f32 v71, s63, v119
    v_mul_f32 v72, s63, v120
    v_mul_f32 v73, s63, v121
    v_mul_f32 v74, s63, v122
    v_mul_f32 v75, s63, v123
    v_mul_f32 v76, s63, v124
    v_mul_f32 v77, s63, v125
    v_mul_f32 v78, s63, v126
    v_mul_f32 v79, s63, v127
    v_exp_f32 v64, v64
    v_exp_f32 v65, v65
    v_exp_f32 v66, v66
    v_exp_f32 v67, v67
    v_exp_f32 v68, v68
    v_exp_f32 v69, v69
    v_exp_f32 v70, v70
    v_exp_f32 v71, v71
    v_exp_f32 v72, v72
    v_exp_f32 v73, v73
    v_exp_f32 v74, v74
    v_exp_f32 v75, v75
    v_exp_f32 v76, v76
    v_exp_f32 v77, v77
    v_exp_f32 v78, v78
    v_exp_f32 v79, v79
    v_pk_add_f32 v[64:65], v[64:65], v[250:251]
    v_pk_add_f32 v[66:67], v[66:67], v[250:251]
    v_pk_add_f32 v[68:69], v[68:69], v[250:251]
    v_pk_add_f32 v[70:71], v[70:71], v[250:251]
    v_pk_add_f32 v[72:73], v[72:73], v[250:251]
    v_pk_add_f32 v[74:75], v[74:75], v[250:251]
    v_pk_add_f32 v[76:77], v[76:77], v[250:251]
    v_pk_add_f32 v[78:79], v[78:79], v[250:251]
    v_rcp_f32 v64, v64
    v_rcp_f32 v65, v65
    v_rcp_f32 v66, v66
    v_rcp_f32 v67, v67
    v_rcp_f32 v68, v68
    v_rcp_f32 v69, v69
    v_rcp_f32 v70, v70
    v_rcp_f32 v71, v71
    v_rcp_f32 v72, v72
    v_rcp_f32 v73, v73
    v_rcp_f32 v74, v74
    v_rcp_f32 v75, v75
    v_rcp_f32 v76, v76
    v_rcp_f32 v77, v77
    v_rcp_f32 v78, v78
    v_rcp_f32 v79, v79
    v_pk_mul_f32 v[112:113], v[112:113], v[64:65]
    v_pk_mul_f32 v[114:115], v[114:115], v[66:67]
    v_pk_mul_f32 v[116:117], v[116:117], v[68:69]
    v_pk_mul_f32 v[118:119], v[118:119], v[70:71]
    v_pk_mul_f32 v[120:121], v[120:121], v[72:73]
    v_pk_mul_f32 v[122:123], v[122:123], v[74:75]
    v_pk_mul_f32 v[124:125], v[124:125], v[76:77]
    v_pk_mul_f32 v[126:127], v[126:127], v[78:79]
    ds_write_b128 v241, v[112:115] offset:12288
    ds_write_b128 v241, v[116:119] offset:13312
    ds_write_b128 v241, v[120:123] offset:14336
    ds_write_b128 v241, v[124:127] offset:15360
    s_mov_b64 exec, 1
    ds_add_u32 v242, v243 offset:8
    s_mov_b64 exec, -1
    s_endpgm
fk_finalize:
    s_lshl_b32 s10, s7, 10
    s_add_u32 s10, s10, 152576
    v_lshlrev_b32 v0, 8, v254
    v_add_u32 v0, 160768, v0
    s_mul_i32 s11, s7, 9216
    v_and_b32 v2, 31, v254
    v_lshl_add_u32 v2, v2, 2, s11
    v_add_u32 v3, s11, v255
    s_mov_b64 exec, 15
fk_fin_wait:
    ds_read_b32 v1, v0
    s_waitcnt lgkmcnt(0)
    v_cmp_le_u32 vcc, s10, v1
    s_cmp_eq_u64 vcc, 15
    s_cbranch_scc1 fk_fin_go
    s_sleep 1
    s_branch fk_fin_wait
fk_fin_go:
    s_mov_b64 exec, -1
    ds_read_b128 v[16:19], v3 offset:0
    ds_read_b128 v[20:23], v3 offset:1024
    ds_read_b32 v24, v2 offset:2048
    ds_read_b128 v[28:31], v3 offset:2304
    ds_read_b128 v[32:35], v3 offset:3328
    ds_read_b32 v36, v2 offset:4352
    ds_read_b128 v[40:43], v3 offset:4608
    ds_read_b128 v[44:47], v3 offset:5632
    ds_read_b32 v48, v2 offset:6656
    ds_read_b128 v[52:55], v3 offset:6912
    ds_read_b128 v[56:59], v3 offset:7936
    ds_read_b32 v60, v2 offset:8960
    s_lshl_b32 s11, s58, 3
    s_add_u32 s11, s11, s7
    s_lshl_b32 s10, s57, 5
    s_add_u32 s10, s10, s11
    s_lshl_b32 s10, s10, 10
    s_add_u32 s10, s10, 3145728
    v_mov_b32 v10, 0x21800000
    v_mov_b32 v11, 0x5d800000
    s_waitcnt lgkmcnt(0)
    v_add_f32 v24, v24, v36
    v_add_f32 v48, v48, v60
    v_add_f32 v8, v24, v48
    v_pk_add_f32 v[16:17], v[16:17], v[28:29]
    v_pk_add_f32 v[40:41], v[40:41], v[52:53]
    v_pk_add_f32 v[18:19], v[18:19], v[30:31]
    v_pk_add_f32 v[42:43], v[42:43], v[54:55]
    v_pk_add_f32 v[20:21], v[20:21], v[32:33]
    v_pk_add_f32 v[44:45], v[44:45], v[56:57]
    v_pk_add_f32 v[22:23], v[22:23], v[34:35]
    v_pk_add_f32 v[46:47], v[46:47], v[58:59]
    v_cmp_gt_f32 vcc, v8, v10
    v_cmp_lt_f32 s[12:13], v8, v11
    v_pk_add_f32 v[0:1], v[16:17], v[40:41]
    v_pk_add_f32 v[2:3], v[18:19], v[42:43]
    v_pk_add_f32 v[4:5], v[20:21], v[44:45]
    v_pk_add_f32 v[6:7], v[22:23], v[46:47]
    s_and_b64 vcc, vcc, s[12:13]
    s_cmp_eq_u64 vcc, -1
    s_cbranch_scc0 fk_slow
fk_fin_store:
    v_rcp_f32 v8, v8
    s_lshl_b32 s11, s11, 6
    v_pk_mul_f32 v[0:1], v[0:1], v[8:9] op_sel_hi:[1,0]
    v_pk_mul_f32 v[2:3], v[2:3], v[8:9] op_sel_hi:[1,0]
    v_pk_mul_f32 v[4:5], v[4:5], v[8:9] op_sel_hi:[1,0]
    v_pk_mul_f32 v[6:7], v[6:7], v[8:9] op_sel_hi:[1,0]
    v_cvt_pk_bf16_f32 v12, v0, v1
    v_cvt_pk_bf16_f32 v13, v2, v3
    v_cvt_pk_bf16_f32 v14, v4, v5
    v_cvt_pk_bf16_f32 v15, v6, v7
    v_min_u32 v12, -2, v12
    v_min_u32 v13, -2, v13
    v_min_u32 v14, -2, v14
    v_min_u32 v15, -2, v15
    buffer_store_dwordx4 v[12:15], v255, s[28:31], s10 offen sc1
    s_lshl_b32 s10, s57, 13
    s_add_u32 s10, s10, s11
    s_add_u32 s10, s10, 264192
    s_setpc_b64 s[8:9]
fk_slow:
    s_lshl_b32 s12, s7, 10
    s_add_u32 s12, s12, 151552
    v_add_u32 v36, s12, v255
    ds_read_b128 v[12:15], v36
    v_and_b32 v36, 15, v254
    v_cmp_eq_u32 vcc, 0, v36
    v_mov_b32 v36, 0x3f803f80
    v_mov_b32 v37, 0
    v_cndmask_b32 v38, v37, v36, vcc
    s_waitcnt lgkmcnt(0)
    v_mov_b32 v36, 0xff800000
    s_mov_b32 s12, 65536
fk_slow1:
    buffer_load_dwordx4 v[16:19], v255, s[28:31], s12 offen sc1
    s_waitcnt vmcnt(0)
    v_mfma_f32_32x32x16_bf16 v[48:63], v[16:19], v[12:15], 0
    s_nop 15
    v_max3_f32 v36, v48, v49, v36
    v_max3_f32 v36, v50, v51, v36
    v_max3_f32 v36, v52, v53, v36
    v_max3_f32 v36, v54, v55, v36
    v_max3_f32 v36, v56, v57, v36
    v_max3_f32 v36, v58, v59, v36
    v_max3_f32 v36, v60, v61, v36
    v_max3_f32 v36, v62, v63, v36
    s_add_u32 s12, s12, 2048
    s_cmp_lt_u32 s12, 196608
    s_cbranch_scc1 fk_slow1
    v_mov_b32 v37, v36
    s_nop 1
    v_permlane32_swap_b32 v36, v37
    s_nop 1
    v_max_f32 v36, v36, v37
    v_sub_f32 v64, 0, v36
    v_mov_b32 v80, 0
    v_sub_f32 v65, 0, v36
    v_mov_b32 v81, 0
    v_sub_f32 v66, 0, v36
    v_mov_b32 v82, 0
    v_sub_f32 v67, 0, v36
    v_mov_b32 v83, 0
    v_sub_f32 v68, 0, v36
    v_mov_b32 v84, 0
    v_sub_f32 v69, 0, v36
    v_mov_b32 v85, 0
    v_sub_f32 v70, 0, v36
    v_mov_b32 v86, 0
    v_sub_f32 v71, 0, v36
    v_mov_b32 v87, 0
    v_sub_f32 v72, 0, v36
    v_mov_b32 v88, 0
    v_sub_f32 v73, 0, v36
    v_mov_b32 v89, 0
    v_sub_f32 v74, 0, v36
    v_mov_b32 v90, 0
    v_sub_f32 v75, 0, v36
    v_mov_b32 v91, 0
    v_sub_f32 v76, 0, v36
    v_mov_b32 v92, 0
    v_sub_f32 v77, 0, v36
    v_mov_b32 v93, 0
    v_sub_f32 v78, 0, v36
    v_mov_b32 v94, 0
    v_sub_f32 v79, 0, v36
    v_mov_b32 v95, 0
    s_mov_b32 s12, 65536
fk_slow2:
    buffer_load_dwordx4 v[16:19], v255, s[28:31], s12 offen sc1
    buffer_load_dwordx4 v[20:23], v255, s[28:31], s12 offen offset:1024 sc1
    v_mov_b32 v24, v38
    v_mov_b32 v25, v38
    v_mov_b32 v26, v38
    v_mov_b32 v27, v38
    s_waitcnt vmcnt(0)
    v_mfma_f32_32x32x16_bf16 v[48:63], v[16:19], v[12:15], v[64:79]
    v_permlane16_swap_b32 v20, v24
    v_permlane16_swap_b32 v21, v25
    v_permlane16_swap_b32 v22, v26
    v_permlane16_swap_b32 v23, v27
    s_nop 15
    v_exp_f32 v48, v48
    v_exp_f32 v49, v49
    v_exp_f32 v50, v50
    v_exp_f32 v51, v51
    v_exp_f32 v52, v52
    v_exp_f32 v53, v53
    v_exp_f32 v54, v54
    v_exp_f32 v55, v55
    v_exp_f32 v56, v56
    v_exp_f32 v57, v57
    v_exp_f32 v58, v58
    v_exp_f32 v59, v59
    v_exp_f32 v60, v60
    v_exp_f32 v61, v61
    v_exp_f32 v62, v62
    v_exp_f32 v63, v63
    v_mov_b32 v28, 0xdddddddd
    s_nop 1
    v_smfmac_f32_32x32x32_bf16 v[80:95], v[20:23], v[48:55], v28
    v_smfmac_f32_32x32x32_bf16 v[80:95], v[24:27], v[56:63], v28
    s_nop 15
    s_add_u32 s12, s12, 2048
    s_cmp_lt_u32 s12, 196608
    s_cbranch_scc1 fk_slow2
    v_mov_b32 v0, v80
    v_mov_b32 v1, v81
    v_mov_b32 v2, v82
    v_mov_b32 v3, v83
    v_mov_b32 v4, v84
    v_mov_b32 v5, v85
    v_mov_b32 v6, v86
    v_mov_b32 v7, v87
    v_mov_b32 v8, v88
    v_mov_b32 v9, v8
    s_nop 1
    v_permlane32_swap_b32 v8, v9
    s_nop 1
    v_add_f32 v8, v8, v9
    s_branch fk_fin_store
.p2alignl 12, 0xbf800000
fk_qentry:
    s_mov_b32 s28, s26
    s_mov_b32 s29, s27
    s_mov_b32 s30, 0x1100000
    s_mov_b32 s31, 0x00020000
    s_mov_b32 s48, s12
    s_mov_b32 s49, s13
    s_mov_b32 s50, 0x80000
    s_mov_b32 s51, 0x00020000
    s_mov_b32 s36, s6
    s_mov_b32 s37, s7
    s_mov_b32 s38, 0x80000
    s_mov_b32 s39, 0x00020000
    s_add_u32 s63, s92, 393216
    s_cmp_lt_u32 s56, 2
    s_cselect_b32 s40, s16, s18
    s_cselect_b32 s41, s17, s19
    s_mov_b32 s42, 1409024
    s_mov_b32 s43, 0x00020000
    s_and_b32 s96, s60, 7
    s_lshl_b32 s96, s96, 1
    s_and_b32 s95, s56, 1
    s_add_u32 s96, s96, s95
    s_mul_i32 s94, s96, 27520
    s_lshr_b32 s95, s59, 1
    s_lshl_b32 s95, s95, 2
    s_add_u32 s95, s95, s58
    s_xor_b32 s95, s95, 2
    s_lshl_b32 s96, 1, s95
    s_sub_u32 s96, s96, 1
    s_and_b32 s96, s96, 8499
    s_bcnt1_i32_b32 s96, s96
    s_mul_i32 s95, s95, 5
    s_add_u32 s95, s95, s96
    s_lshl_b32 s95, s95, 5
    s_add_u32 s94, s94, s95
    v_lshrrev_b32 v13, 1, v254
    v_mul_u32_u24 v10, 2752, v13
    v_and_b32 v11, 1, v254
    v_mul_u32_u24 v11, 156, v11
    v_add_u32 v10, v10, v11
    s_mov_b32 exec_lo, 0xfffff
    s_mov_b32 exec_hi, 0
    buffer_load_dword v15, v10, s[40:43], s94 offen
    s_mov_b64 exec, -1
    v_lshrrev_b32 v14, 5, v254
    v_bfe_u32 v7, v254, 2, 2
    v_lshl_add_u32 v9, v14, 3, v7
    v_lshlrev_b32 v12, 8, v9
    v_xor_b32 v7, s56, v7
    v_lshl_add_u32 v12, v7, 6, v12
    v_bfe_u32 v7, v254, 4, 1
    v_lshl_add_u32 v12, v7, 5, v12
    v_and_b32 v8, 3, v254
    v_lshl_add_u32 v12, v8, 3, v12
    v_add_u32 v240, 53248, v12
    v_add_u32 v241, 49152, v240
    v_add_u32 v242, s93, v255
    v_lshlrev_b32 v243, 6, v254
    v_and_b32 v7, 15, v254
    v_cmp_eq_u32 vcc, 0, v7
    v_mov_b32 v247, 0x3f803f80
    v_mov_b32 v248, 0
    v_cndmask_b32 v250, v248, v247, vcc
    v_mov_b32 v251, 159748
    v_mov_b32 v252, 1
    v_mov_b32 v248, 159744
    v_mov_b32 v68, v250
    v_mov_b32 v69, v250
    v_mov_b32 v70, v250
    v_mov_b32 v71, v250
    v_mov_b32 v76, v250
    v_mov_b32 v77, v250
    v_mov_b32 v78, v250
    v_mov_b32 v79, v250
    v_mov_b32 v84, v250
    v_mov_b32 v85, v250
    v_mov_b32 v86, v250
    v_mov_b32 v87, v250
    v_mov_b32 v92, v250
    v_mov_b32 v93, v250
    v_mov_b32 v94, v250
    v_mov_b32 v95, v250
    v_mov_b32 v100, v250
    v_mov_b32 v101, v250
    v_mov_b32 v102, v250
    v_mov_b32 v103, v250
    v_mov_b32 v108, v250
    v_mov_b32 v109, v250
    v_mov_b32 v110, v250
    v_mov_b32 v111, v250
    v_mov_b32 v116, v250
    v_mov_b32 v117, v250
    v_mov_b32 v118, v250
    v_mov_b32 v119, v250
    v_mov_b32 v124, v250
    v_mov_b32 v125, v250
    v_mov_b32 v126, v250
    v_mov_b32 v127, v250
    v_mov_b32 v132, v250
    v_mov_b32 v133, v250
    v_mov_b32 v134, v250
    v_mov_b32 v135, v250
    v_mov_b32 v140, v250
    v_mov_b32 v141, v250
    v_mov_b32 v142, v250
    v_mov_b32 v143, v250
    v_mov_b32 v148, v250
    v_mov_b32 v149, v250
    v_mov_b32 v150, v250
    v_mov_b32 v151, v250
    v_mov_b32 v156, v250
    v_mov_b32 v157, v250
    v_mov_b32 v158, v250
    v_mov_b32 v159, v250
    v_mov_b32 v164, v250
    v_mov_b32 v165, v250
    v_mov_b32 v166, v250
    v_mov_b32 v167, v250
    v_mov_b32 v172, v250
    v_mov_b32 v173, v250
    v_mov_b32 v174, v250
    v_mov_b32 v175, v250
    v_mov_b32 v180, v250
    v_mov_b32 v181, v250
    v_mov_b32 v182, v250
    v_mov_b32 v183, v250
    v_mov_b32 v188, v250
    v_mov_b32 v189, v250
    v_mov_b32 v190, v250
    v_mov_b32 v191, v250
fk_qdma:
    s_xor_b32 s97, s62, s44
    buffer_load_dwordx4 v6, s[36:39], s97 offen lds
    s_add_u32 s62, s62, 16384
    s_add_u32 m0, m0, 4096
    s_cmp_lt_u32 s62, s63
    s_cbranch_scc1 fk_qdma
    s_xor_b32 s97, s62, s44
    buffer_load_dwordx4 v[16:19], v6, s[36:39], s97 offen
    s_add_u32 s62, s62, 16384
    s_xor_b32 s97, s62, s44
    buffer_load_dwordx4 v[20:23], v6, s[36:39], s97 offen
    s_add_u32 s62, s62, 16384
    s_xor_b32 s97, s62, s44
    buffer_load_dwordx4 v[24:27], v6, s[36:39], s97 offen
    s_add_u32 s62, s62, 16384
    s_xor_b32 s97, s62, s44
    buffer_load_dwordx4 v[28:31], v6, s[36:39], s97 offen
    s_add_u32 s62, s62, 16384
    s_xor_b32 s97, s62, s44
    buffer_load_dwordx4 v[32:35], v6, s[36:39], s97 offen
    s_add_u32 s62, s62, 16384
    s_xor_b32 s97, s62, s44
    buffer_load_dwordx4 v[36:39], v6, s[36:39], s97 offen
    s_add_u32 s62, s62, 16384
    s_xor_b32 s97, s62, s44
    buffer_load_dwordx4 v[40:43], v6, s[36:39], s97 offen
    s_add_u32 s62, s62, 16384
    s_xor_b32 s97, s62, s44
    buffer_load_dwordx4 v[44:47], v6, s[36:39], s97 offen
    s_add_u32 s62, s62, 16384
    s_waitcnt vmcnt(20)
    s_mov_b64 exec, 1
    ds_add_u32 v251, v252
    s_mov_b64 exec, -1
fk_lw_60:
    ds_read_b32 v247, v248
    s_waitcnt lgkmcnt(0)
    v_readfirstlane_b32 s97, v247
    s_cmp_ge_u32 s97, 8
    s_cbranch_scc1 fk_lwk_61
    s_sleep 1
    s_branch fk_lw_60
fk_lwk_61:
    ds_read_b32 v253, v248 offset:12
    ds_read_b32 v249, v251
    s_waitcnt lgkmcnt(0)
fk_sbr_62:
    v_readfirstlane_b32 s97, v249
    s_cmp_ge_u32 s97, 4
    s_cbranch_scc1 fk_sbk_63
    ds_read_b32 v249, v251
    s_waitcnt lgkmcnt(0)
    s_branch fk_sbr_62
fk_sbk_63:
    s_lshl_b32 s95, s56, 15
    s_add_u32 s95, s95, 65536
    s_lshl_b32 s92, s56, 11
    s_add_u32 s92, s92, 8192
    ds_read_b128 v[208:211], v255 offset:0
    ds_read_b64_tr_b16 v[224:225], v240 offset:0
    ds_read_b64_tr_b16 v[226:227], v240 offset:1024
    ds_read_b128 v[212:215], v255 offset:1024
    ds_read_b64_tr_b16 v[228:229], v240 offset:4096
    ds_read_b64_tr_b16 v[230:231], v240 offset:5120
    ds_read_b128 v[216:219], v255 offset:2048
    ds_read_b64_tr_b16 v[232:233], v240 offset:8192
    ds_read_b64_tr_b16 v[234:235], v240 offset:9216
    s_waitcnt lgkmcnt(6)
    v_mfma_f32_32x32x16_bf16 v[192:207], v[224:227], v[208:211], 0
    ds_read_b128 v[220:223], v255 offset:3072
    ds_read_b64_tr_b16 v[236:237], v240 offset:12288
    ds_read_b64_tr_b16 v[238:239], v240 offset:13312
    s_waitcnt lgkmcnt(6)
    v_mfma_f32_32x32x16_bf16 v[192:207], v[228:231], v[212:215], v[192:207]
    v_readfirstlane_b32 s61, v253
    ds_read_b128 v[208:211], v255 offset:4096
    ds_read_b64_tr_b16 v[224:225], v240 offset:16384
    ds_read_b64_tr_b16 v[226:227], v240 offset:17408
    s_waitcnt lgkmcnt(6)
    v_mfma_f32_32x32x16_bf16 v[192:207], v[232:235], v[216:219], v[192:207]
    ds_read_b128 v[212:215], v255 offset:5120
    ds_read_b64_tr_b16 v[228:229], v240 offset:20480
    ds_read_b64_tr_b16 v[230:231], v240 offset:21504
    s_waitcnt lgkmcnt(6)
    v_mfma_f32_32x32x16_bf16 v[192:207], v[236:239], v[220:223], v[192:207]
    ds_read_b128 v[216:219], v255 offset:6144
    ds_read_b64_tr_b16 v[232:233], v240 offset:24576
    ds_read_b64_tr_b16 v[234:235], v240 offset:25600
    s_waitcnt lgkmcnt(6)
    v_mfma_f32_32x32x16_bf16 v[192:207], v[224:227], v[208:211], v[192:207]
    ds_read_b128 v[220:223], v255 offset:7168
    ds_read_b64_tr_b16 v[236:237], v240 offset:28672
    ds_read_b64_tr_b16 v[238:239], v240 offset:29696
    s_waitcnt lgkmcnt(6)
    v_mfma_f32_32x32x16_bf16 v[192:207], v[228:231], v[212:215], v[192:207]
    ds_read_b128 v[208:211], v255 offset:8192
    ds_read_b64_tr_b16 v[224:225], v240 offset:32768
    ds_read_b64_tr_b16 v[226:227], v240 offset:33792
    s_waitcnt lgkmcnt(6)
    v_mfma_f32_32x32x16_bf16 v[192:207], v[232:235], v[216:219], v[192:207]
    ds_read_b128 v[212:215], v255 offset:9216
    ds_read_b64_tr_b16 v[228:229], v240 offset:36864
    ds_read_b64_tr_b16 v[230:231], v240 offset:37888
    s_waitcnt lgkmcnt(6)
    v_mfma_f32_32x32x16_bf16 v[192:207], v[236:239], v[220:223], v[192:207]
    ds_read_b128 v[216:219], v255 offset:10240
    ds_read_b64_tr_b16 v[232:233], v240 offset:40960
    ds_read_b64_tr_b16 v[234:235], v240 offset:41984
    s_waitcnt lgkmcnt(6)
    v_mfma_f32_32x32x16_bf16 v[192:207], v[224:227], v[208:211], v[192:207]
    ds_read_b128 v[220:223], v255 offset:11264
    ds_read_b64_tr_b16 v[236:237], v240 offset:45056
    ds_read_b64_tr_b16 v[238:239], v240 offset:46080
    s_waitcnt lgkmcnt(6)
    v_mfma_f32_32x32x16_bf16 v[192:207], v[228:231], v[212:215], v[192:207]
    s_waitcnt vmcnt(0)
    s_mov_b64 exec, 1
    ds_add_u32 v251, v252
    s_mov_b64 exec, -1
    ds_read_b32 v249, v251
    s_waitcnt lgkmcnt(0)
fk_sbr_64:
    v_readfirstlane_b32 s97, v249
    s_cmp_ge_u32 s97, 8
    s_cbranch_scc1 fk_sbk_65
    ds_read_b32 v249, v251
    s_waitcnt lgkmcnt(0)
    s_branch fk_sbr_64
fk_sbk_65:
    ds_read_b128 v[208:211], v255 offset:12288
    ds_read_b64_tr_b16 v[224:225], v241 offset:0
    ds_read_b64_tr_b16 v[226:227], v241 offset:1024
    v_mfma_f32_32x32x16_bf16 v[192:207], v[232:235], v[216:219], v[192:207]
    ds_write_b128 v242, v[16:19] offset:0
    ds_read_b128 v[212:215], v255 offset:13312
    ds_read_b64_tr_b16 v[228:229], v241 offset:4096
    ds_read_b64_tr_b16 v[230:231], v241 offset:5120
    v_mfma_f32_32x32x16_bf16 v[192:207], v[236:239], v[220:223], v[192:207]
    ds_write_b128 v242, v[20:23] offset:4096
    ds_read_b128 v[216:219], v255 offset:14336
    ds_read_b64_tr_b16 v[232:233], v241 offset:8192
    ds_read_b64_tr_b16 v[234:235], v241 offset:9216
    s_waitcnt lgkmcnt(8)
    v_mfma_f32_32x32x16_bf16 v[192:207], v[224:227], v[208:211], v[192:207]
    ds_write_b128 v242, v[24:27] offset:8192
    ds_read_b128 v[220:223], v255 offset:15360
    ds_read_b64_tr_b16 v[236:237], v241 offset:12288
    ds_read_b64_tr_b16 v[238:239], v241 offset:13312
    s_waitcnt lgkmcnt(8)
    v_mfma_f32_32x32x16_bf16 v[192:207], v[228:231], v[212:215], v[192:207]
    ds_write_b128 v242, v[28:31] offset:12288
    ds_read_b128 v[208:211], v255 offset:16384
    ds_read_b64_tr_b16 v[224:225], v241 offset:16384
    ds_read_b64_tr_b16 v[226:227], v241 offset:17408
    s_waitcnt lgkmcnt(8)
    v_mfma_f32_32x32x16_bf16 v[192:207], v[232:235], v[216:219], v[192:207]
    ds_write_b128 v242, v[32:35] offset:16384
    ds_read_b128 v[212:215], v255 offset:17408
    ds_read_b64_tr_b16 v[228:229], v241 offset:20480
    ds_read_b64_tr_b16 v[230:231], v241 offset:21504
    s_waitcnt lgkmcnt(8)
    v_mfma_f32_32x32x16_bf16 v[192:207], v[236:239], v[220:223], v[192:207]
    ds_write_b128 v242, v[36:39] offset:20480
    ds_read_b128 v[216:219], v255 offset:18432
    ds_read_b64_tr_b16 v[232:233], v241 offset:24576
    ds_read_b64_tr_b16 v[234:235], v241 offset:25600
    s_waitcnt lgkmcnt(8)
    v_mfma_f32_32x32x16_bf16 v[192:207], v[224:227], v[208:211], v[192:207]
    ds_write_b128 v242, v[40:43] offset:24576
    ds_read_b128 v[220:223], v255 offset:19456
    ds_read_b64_tr_b16 v[236:237], v241 offset:28672
    ds_read_b64_tr_b16 v[238:239], v241 offset:29696
    s_waitcnt lgkmcnt(8)
    v_mfma_f32_32x32x16_bf16 v[192:207], v[228:231], v[212:215], v[192:207]
    ds_write_b128 v242, v[44:47] offset:28672
    ds_read_b128 v[208:211], v255 offset:20480
    ds_read_b64_tr_b16 v[224:225], v241 offset:32768
    ds_read_b64_tr_b16 v[226:227], v241 offset:33792
    s_waitcnt lgkmcnt(8)
    v_mfma_f32_32x32x16_bf16 v[192:207], v[232:235], v[216:219], v[192:207]
    ds_read_b128 v[212:215], v255 offset:21504
    ds_read_b64_tr_b16 v[228:229], v241 offset:36864
    ds_read_b64_tr_b16 v[230:231], v241 offset:37888
    s_waitcnt lgkmcnt(7)
    v_mfma_f32_32x32x16_bf16 v[192:207], v[236:239], v[220:223], v[192:207]
    s_waitcnt lgkmcnt(6)
    s_mov_b64 exec, 1
    ds_add_u32 v251, v252
    s_mov_b64 exec, -1
    ds_read_b128 v[216:219], v255 offset:22528
    ds_read_b64_tr_b16 v[232:233], v241 offset:40960
    ds_read_b64_tr_b16 v[234:235], v241 offset:41984
    s_waitcnt lgkmcnt(7)
    v_mfma_f32_32x32x16_bf16 v[192:207], v[224:227], v[208:211], v[192:207]
    ds_read_b128 v[220:223], v255 offset:23552
    ds_read_b64_tr_b16 v[236:237], v241 offset:45056
    ds_read_b64_tr_b16 v[238:239], v241 offset:46080
    s_waitcnt lgkmcnt(7)
    v_mfma_f32_32x32x16_bf16 v[192:207], v[228:231], v[212:215], v[192:207]
    ds_read_b32 v249, v251
    s_waitcnt lgkmcnt(0)
fk_sbr_66:
    v_readfirstlane_b32 s97, v249
    s_cmp_ge_u32 s97, 12
    s_cbranch_scc1 fk_sbk_67
    ds_read_b32 v249, v251
    s_waitcnt lgkmcnt(0)
    s_branch fk_sbr_66
fk_sbk_67:
    ds_read_b128 v[208:211], v255 offset:24576
    ds_read_b64_tr_b16 v[224:225], v240 offset:0
    ds_read_b64_tr_b16 v[226:227], v240 offset:1024
    v_mfma_f32_32x32x16_bf16 v[192:207], v[232:235], v[216:219], v[192:207]
    ds_read_b128 v[212:215], v255 offset:25600
    ds_read_b64_tr_b16 v[228:229], v240 offset:4096
    ds_read_b64_tr_b16 v[230:231], v240 offset:5120
    v_mfma_f32_32x32x16_bf16 v[192:207], v[236:239], v[220:223], v[192:207]
    ds_read_b128 v[216:219], v255 offset:26624
    ds_read_b64_tr_b16 v[232:233], v240 offset:8192
    ds_read_b64_tr_b16 v[234:235], v240 offset:9216
    s_waitcnt lgkmcnt(6)
    v_mfma_f32_32x32x16_bf16 v[192:207], v[224:227], v[208:211], v[192:207]
    ds_read_b128 v[220:223], v255 offset:27648
    ds_read_b64_tr_b16 v[236:237], v240 offset:12288
    ds_read_b64_tr_b16 v[238:239], v240 offset:13312
    s_waitcnt lgkmcnt(6)
    v_mfma_f32_32x32x16_bf16 v[192:207], v[228:231], v[212:215], v[192:207]
    ds_read_b128 v[208:211], v255 offset:28672
    ds_read_b64_tr_b16 v[224:225], v240 offset:16384
    ds_read_b64_tr_b16 v[226:227], v240 offset:17408
    s_waitcnt lgkmcnt(6)
    v_mfma_f32_32x32x16_bf16 v[192:207], v[232:235], v[216:219], v[192:207]
    ds_read_b128 v[212:215], v255 offset:29696
    ds_read_b64_tr_b16 v[228:229], v240 offset:20480
    ds_read_b64_tr_b16 v[230:231], v240 offset:21504
    s_waitcnt lgkmcnt(6)
    v_mfma_f32_32x32x16_bf16 v[192:207], v[236:239], v[220:223], v[192:207]
    ds_read_b128 v[216:219], v255 offset:30720
    ds_read_b64_tr_b16 v[232:233], v240 offset:24576
    ds_read_b64_tr_b16 v[234:235], v240 offset:25600
    s_waitcnt lgkmcnt(6)
    v_mfma_f32_32x32x16_bf16 v[192:207], v[224:227], v[208:211], v[192:207]
    ds_read_b128 v[220:223], v255 offset:31744
    ds_read_b64_tr_b16 v[236:237], v240 offset:28672
    ds_read_b64_tr_b16 v[238:239], v240 offset:29696
    s_waitcnt lgkmcnt(6)
    v_mfma_f32_32x32x16_bf16 v[192:207], v[228:231], v[212:215], v[192:207]
    s_waitcnt lgkmcnt(3)
    v_mfma_f32_32x32x16_bf16 v[192:207], v[232:235], v[216:219], v[192:207]
    s_waitcnt lgkmcnt(0)
    v_mfma_f32_32x32x16_bf16 v[192:207], v[236:239], v[220:223], v[192:207]
    s_mov_b32 s96, 0
    s_nop 1
    s_mov_b32 s63, 0x3eb8aa3b
    s_lshl_b32 s62, s56, 11
    s_add_u32 s62, s62, 151552
    v_add_u32 v247, s62, v255
    s_mul_i32 s62, s56, 2304
    v_add_u32 v244, s62, v255
    v_lshl_add_u32 v245, v254, 2, s62
    v_add_u32 v246, 151552, v255
    s_nop 3
    v_mul_f32 v192, s63, v192
    v_mul_f32 v193, s63, v193
    v_mul_f32 v194, s63, v194
    v_mul_f32 v195, s63, v195
    v_mul_f32 v196, s63, v196
    v_mul_f32 v197, s63, v197
    v_mul_f32 v198, s63, v198
    v_mul_f32 v199, s63, v199
    v_mul_f32 v200, s63, v200
    v_mul_f32 v201, s63, v201
    v_mul_f32 v202, s63, v202
    v_mul_f32 v203, s63, v203
    v_mul_f32 v204, s63, v204
    v_mul_f32 v205, s63, v205
    v_mul_f32 v206, s63, v206
    v_mul_f32 v207, s63, v207
    v_cvt_pk_bf16_f32 v208, v192, v193
    v_cvt_pk_bf16_f32 v209, v194, v195
    v_cvt_pk_bf16_f32 v210, v196, v197
    v_cvt_pk_bf16_f32 v211, v198, v199
    v_cvt_pk_bf16_f32 v212, v200, v201
    v_cvt_pk_bf16_f32 v213, v202, v203
    v_cvt_pk_bf16_f32 v214, v204, v205
    v_cvt_pk_bf16_f32 v215, v206, v207
    ds_write_b128 v247, v[208:211]
    ds_write_b128 v247, v[212:215] offset:1024
    s_lshl_b32 s62, s56, 8
    s_add_u32 s62, s62, 160768
    v_lshl_add_u32 v253, v254, 2, s62
    ds_write_b32 v253, v252
    s_waitcnt lgkmcnt(0)
    s_mov_b64 exec, 1
    ds_add_u32 v251, v252
    s_mov_b64 exec, -1
    s_cmp_eq_u32 s96, 1
    s_cbranch_scc1 fk_kv_issued
    s_mov_b32 s16, 0xffffffff
    s_mov_b32 s17, 0
    s_mov_b32 s97, 0
fk_poll_68:
    s_mov_b64 exec, s[16:17]
    buffer_load_dword v248, v243, s[28:31], s92 offen sc1
    s_waitcnt vmcnt(0)
    v_cmp_eq_u32 vcc, s61, v248
    s_mov_b64 exec, -1
    s_cmp_eq_u64 vcc, s[16:17]
    s_cbranch_scc1 fk_pollok_69
    s_sleep 2
    s_add_u32 s97, s97, 1
    s_cmp_lt_u32 s97, 32768
    s_cbranch_scc1 fk_poll_68
fk_pollok_69:
    s_add_u32 s62, s60, 0
    s_and_b32 s62, s62, 15
    s_lshl_b32 s62, s62, 11
    s_add_u32 s62, s62, s95
    buffer_load_dwordx4 v[0:3], v255, s[28:31], s62 offen sc1
    buffer_load_dwordx4 v[64:67], v255, s[28:31], s62 offen offset:1024 sc1
    s_add_u32 s62, s60, 1
    s_and_b32 s62, s62, 15
    s_lshl_b32 s62, s62, 11
    s_add_u32 s62, s62, s95
    buffer_load_dwordx4 v[4:7], v255, s[28:31], s62 offen sc1
    buffer_load_dwordx4 v[72:75], v255, s[28:31], s62 offen offset:1024 sc1
    s_add_u32 s62, s60, 2
    s_and_b32 s62, s62, 15
    s_lshl_b32 s62, s62, 11
    s_add_u32 s62, s62, s95
    buffer_load_dwordx4 v[8:11], v255, s[28:31], s62 offen sc1
    buffer_load_dwordx4 v[80:83], v255, s[28:31], s62 offen offset:1024 sc1
    s_add_u32 s62, s60, 3
    s_and_b32 s62, s62, 15
    s_lshl_b32 s62, s62, 11
    s_add_u32 s62, s62, s95
    buffer_load_dwordx4 v[12:15], v255, s[28:31], s62 offen sc1
    buffer_load_dwordx4 v[88:91], v255, s[28:31], s62 offen offset:1024 sc1
    s_add_u32 s62, s60, 4
    s_and_b32 s62, s62, 15
    s_lshl_b32 s62, s62, 11
    s_add_u32 s62, s62, s95
    buffer_load_dwordx4 v[16:19], v255, s[28:31], s62 offen sc1
    buffer_load_dwordx4 v[96:99], v255, s[28:31], s62 offen offset:1024 sc1
    s_add_u32 s62, s60, 5
    s_and_b32 s62, s62, 15
    s_lshl_b32 s62, s62, 11
    s_add_u32 s62, s62, s95
    buffer_load_dwordx4 v[20:23], v255, s[28:31], s62 offen sc1
    buffer_load_dwordx4 v[104:107], v255, s[28:31], s62 offen offset:1024 sc1
fk_kv_issued:
    ds_read_b32 v249, v251
    s_waitcnt lgkmcnt(0)
fk_sbr_70:
    v_readfirstlane_b32 s97, v249
    s_cmp_ge_u32 s97, 16
    s_cbranch_scc1 fk_sbk_71
    ds_read_b32 v249, v251
    s_waitcnt lgkmcnt(0)
    s_branch fk_sbr_70
fk_sbk_71:
    ds_read_b128 v[240:243], v246
    s_mov_b32 s94, 7
    s_waitcnt lgkmcnt(0)
    s_mov_b32 s44, s4
    s_mov_b32 s45, s5
    s_mov_b32 s46, 0x200000
    s_mov_b32 s47, 0x00020000
    s_mov_b32 s52, s22
    s_mov_b32 s53, s23
    s_mov_b32 s54, 0x200000
    s_mov_b32 s55, 0x00020000
    s_mul_i32 s18, s56, 9216
    s_and_b32 s62, s57, 1
    s_lshl_b32 s62, s62, 2
    s_add_u32 s62, s62, s58
    s_lshl_b32 s21, s62, 7
    s_lshl_b32 s62, s56, 17
    s_add_u32 s19, s21, s62
    s_add_u32 s19, s19, 65536
    s_and_b32 s63, s57, 62
    s_and_b32 s62, s56, 1
    s_add_u32 s63, s63, s62
    s_lshl_b32 s22, s63, 13
    s_add_u32 s22, s22, 264192
    s_lshl_b32 s63, s63, 15
    s_add_u32 s20, s63, 3145728
    s_add_u32 s21, s21, s63
    s_lshr_b32 s62, s56, 1
    s_lshl_b32 s62, s62, 6
    s_add_u32 s21, s21, s62
    v_mov_b32 v250, 0xdddddddd
    v_mov_b32 v248, 0
    v_mov_b32 v249, 0
    s_nop 1
    v_mfma_f32_32x32x8_bf16 v[224:239], v[248:249], v[248:249], 0
    s_waitcnt vmcnt(11)
    v_mfma_f32_32x32x16_bf16 v[192:207], v[0:3], v[240:243], 0
    s_nop 11
    s_add_u32 s62, s60, 6
    s_and_b32 s62, s62, 15
    s_lshl_b32 s62, s62, 11
    s_add_u32 s62, s62, s95
    buffer_load_dwordx4 v[24:27], v255, s[28:31], s62 offen sc1
    buffer_load_dwordx4 v[112:115], v255, s[28:31], s62 offen offset:1024 sc1
    v_exp_f32 v192, v192
    v_exp_f32 v193, v193
    v_exp_f32 v194, v194
    v_exp_f32 v195, v195
    v_exp_f32 v196, v196
    s_waitcnt vmcnt(11)
    v_mfma_f32_32x32x16_bf16 v[208:223], v[4:7], v[240:243], 0
    v_permlane16_swap_b32 v64, v68
    v_permlane16_swap_b32 v65, v69
    v_permlane16_swap_b32 v66, v70
    v_permlane16_swap_b32 v67, v71
    v_exp_f32 v197, v197
    v_exp_f32 v198, v198
    v_exp_f32 v199, v199
    v_exp_f32 v200, v200
    v_exp_f32 v201, v201
    v_exp_f32 v202, v202
    v_exp_f32 v203, v203
    v_exp_f32 v204, v204
    v_exp_f32 v205, v205
    v_exp_f32 v206, v206
    v_smfmac_f32_32x32x32_bf16 v[224:239], v[64:67], v[192:199], v250
    v_exp_f32 v207, v207
    s_add_u32 s62, s60, 7
    s_and_b32 s62, s62, 15
    s_lshl_b32 s62, s62, 11
    s_add_u32 s62, s62, s95
    buffer_load_dwordx4 v[28:31], v255, s[28:31], s62 offen sc1
    buffer_load_dwordx4 v[120:123], v255, s[28:31], s62 offen offset:1024 sc1
    v_exp_f32 v208, v208
    v_exp_f32 v209, v209
    v_smfmac_f32_32x32x32_bf16 v[224:239], v[68:71], v[200:207], v250
    v_exp_f32 v210, v210
    v_exp_f32 v211, v211
    v_exp_f32 v212, v212
    s_waitcnt vmcnt(11)
    v_mfma_f32_32x32x16_bf16 v[192:207], v[8:11], v[240:243], 0
    v_permlane16_swap_b32 v72, v76
    v_permlane16_swap_b32 v73, v77
    v_permlane16_swap_b32 v74, v78
    v_permlane16_swap_b32 v75, v79
    v_exp_f32 v213, v213
    v_exp_f32 v214, v214
    v_exp_f32 v215, v215
    v_exp_f32 v216, v216
    v_exp_f32 v217, v217
    v_exp_f32 v218, v218
    v_exp_f32 v219, v219
    v_exp_f32 v220, v220
    v_exp_f32 v221, v221
    v_exp_f32 v222, v222
    v_smfmac_f32_32x32x32_bf16 v[224:239], v[72:75], v[208:215], v250
    v_exp_f32 v223, v223
    s_add_u32 s62, s60, 8
    s_and_b32 s62, s62, 15
    s_lshl_b32 s62, s62, 11
    s_add_u32 s62, s62, s95
    buffer_load_dwordx4 v[32:35], v255, s[28:31], s62 offen sc1
    buffer_load_dwordx4 v[128:131], v255, s[28:31], s62 offen offset:1024 sc1
    v_exp_f32 v192, v192
    v_exp_f32 v193, v193
    v_smfmac_f32_32x32x32_bf16 v[224:239], v[76:79], v[216:223], v250
    v_exp_f32 v194, v194
    v_exp_f32 v195, v195
    v_exp_f32 v196, v196
    s_waitcnt vmcnt(11)
    v_mfma_f32_32x32x16_bf16 v[208:223], v[12:15], v[240:243], 0
    v_permlane16_swap_b32 v80, v84
    v_permlane16_swap_b32 v81, v85
    v_permlane16_swap_b32 v82, v86
    v_permlane16_swap_b32 v83, v87
    v_exp_f32 v197, v197
    v_exp_f32 v198, v198
    v_exp_f32 v199, v199
    v_exp_f32 v200, v200
    v_exp_f32 v201, v201
    v_exp_f32 v202, v202
    v_exp_f32 v203, v203
    v_exp_f32 v204, v204
    v_exp_f32 v205, v205
    v_exp_f32 v206, v206
    v_smfmac_f32_32x32x32_bf16 v[224:239], v[80:83], v[192:199], v250
    v_exp_f32 v207, v207
    s_add_u32 s62, s60, 9
    s_and_b32 s62, s62, 15
    s_lshl_b32 s62, s62, 11
    s_add_u32 s62, s62, s95
    buffer_load_dwordx4 v[36:39], v255, s[28:31], s62 offen sc1
    buffer_load_dwordx4 v[136:139], v255, s[28:31], s62 offen offset:1024 sc1
    v_exp_f32 v208, v208
    v_exp_f32 v209, v209
    v_smfmac_f32_32x32x32_bf16 v[224:239], v[84:87], v[200:207], v250
    v_exp_f32 v210, v210
    v_exp_f32 v211, v211
    v_exp_f32 v212, v212
    s_waitcnt vmcnt(11)
    v_mfma_f32_32x32x16_bf16 v[192:207], v[16:19], v[240:243], 0
    v_permlane16_swap_b32 v88, v92
    v_permlane16_swap_b32 v89, v93
    v_permlane16_swap_b32 v90, v94
    v_permlane16_swap_b32 v91, v95
    v_exp_f32 v213, v213
    v_exp_f32 v214, v214
    v_exp_f32 v215, v215
    v_exp_f32 v216, v216
    v_exp_f32 v217, v217
    v_exp_f32 v218, v218
    v_exp_f32 v219, v219
    v_exp_f32 v220, v220
    v_exp_f32 v221, v221
    v_exp_f32 v222, v222
    v_smfmac_f32_32x32x32_bf16 v[224:239], v[88:91], v[208:215], v250
    v_exp_f32 v223, v223
    s_add_u32 s62, s60, 10
    s_and_b32 s62, s62, 15
    s_lshl_b32 s62, s62, 11
    s_add_u32 s62, s62, s95
    buffer_load_dwordx4 v[40:43], v255, s[28:31], s62 offen sc1
    buffer_load_dwordx4 v[144:147], v255, s[28:31], s62 offen offset:1024 sc1
    v_exp_f32 v192, v192
    v_exp_f32 v193, v193
    v_smfmac_f32_32x32x32_bf16 v[224:239], v[92:95], v[216:223], v250
    v_exp_f32 v194, v194
    v_exp_f32 v195, v195
    v_exp_f32 v196, v196
    s_waitcnt vmcnt(11)
    v_mfma_f32_32x32x16_bf16 v[208:223], v[20:23], v[240:243], 0
    v_permlane16_swap_b32 v96, v100
    v_permlane16_swap_b32 v97, v101
    v_permlane16_swap_b32 v98, v102
    v_permlane16_swap_b32 v99, v103
    v_exp_f32 v197, v197
    v_exp_f32 v198, v198
    v_exp_f32 v199, v199
    v_exp_f32 v200, v200
    v_exp_f32 v201, v201
    v_exp_f32 v202, v202
    v_exp_f32 v203, v203
    v_exp_f32 v204, v204
    v_exp_f32 v205, v205
    v_exp_f32 v206, v206
    v_smfmac_f32_32x32x32_bf16 v[224:239], v[96:99], v[192:199], v250
    v_exp_f32 v207, v207
    s_add_u32 s62, s60, 11
    s_and_b32 s62, s62, 15
    s_lshl_b32 s62, s62, 11
    s_add_u32 s62, s62, s95
    buffer_load_dwordx4 v[44:47], v255, s[28:31], s62 offen sc1
    buffer_load_dwordx4 v[152:155], v255, s[28:31], s62 offen offset:1024 sc1
    v_exp_f32 v208, v208
    v_exp_f32 v209, v209
    v_smfmac_f32_32x32x32_bf16 v[224:239], v[100:103], v[200:207], v250
    v_exp_f32 v210, v210
    v_exp_f32 v211, v211
    v_exp_f32 v212, v212
    s_waitcnt vmcnt(11)
    v_mfma_f32_32x32x16_bf16 v[192:207], v[24:27], v[240:243], 0
    v_permlane16_swap_b32 v104, v108
    v_permlane16_swap_b32 v105, v109
    v_permlane16_swap_b32 v106, v110
    v_permlane16_swap_b32 v107, v111
    v_exp_f32 v213, v213
    v_exp_f32 v214, v214
    v_exp_f32 v215, v215
    v_exp_f32 v216, v216
    v_exp_f32 v217, v217
    v_exp_f32 v218, v218
    v_exp_f32 v219, v219
    v_exp_f32 v220, v220
    v_exp_f32 v221, v221
    v_exp_f32 v222, v222
    v_smfmac_f32_32x32x32_bf16 v[224:239], v[104:107], v[208:215], v250
    v_exp_f32 v223, v223
    s_add_u32 s62, s60, 12
    s_and_b32 s62, s62, 15
    s_lshl_b32 s62, s62, 11
    s_add_u32 s62, s62, s95
    buffer_load_dwordx4 v[48:51], v255, s[28:31], s62 offen sc1
    buffer_load_dwordx4 v[160:163], v255, s[28:31], s62 offen offset:1024 sc1
    v_exp_f32 v192, v192
    v_exp_f32 v193, v193
    v_smfmac_f32_32x32x32_bf16 v[224:239], v[108:111], v[216:223], v250
    v_exp_f32 v194, v194
    v_exp_f32 v195, v195
    v_exp_f32 v196, v196
    s_waitcnt vmcnt(11)
    v_mfma_f32_32x32x16_bf16 v[208:223], v[28:31], v[240:243], 0
    v_permlane16_swap_b32 v112, v116
    v_permlane16_swap_b32 v113, v117
    v_permlane16_swap_b32 v114, v118
    v_permlane16_swap_b32 v115, v119
    v_exp_f32 v197, v197
    v_exp_f32 v198, v198
    v_exp_f32 v199, v199
    v_exp_f32 v200, v200
    v_exp_f32 v201, v201
    v_exp_f32 v202, v202
    v_exp_f32 v203, v203
    v_exp_f32 v204, v204
    v_exp_f32 v205, v205
    v_exp_f32 v206, v206
    v_smfmac_f32_32x32x32_bf16 v[224:239], v[112:115], v[192:199], v250
    v_exp_f32 v207, v207
    s_add_u32 s62, s60, 13
    s_and_b32 s62, s62, 15
    s_lshl_b32 s62, s62, 11
    s_add_u32 s62, s62, s95
    buffer_load_dwordx4 v[52:55], v255, s[28:31], s62 offen sc1
    buffer_load_dwordx4 v[168:171], v255, s[28:31], s62 offen offset:1024 sc1
    v_exp_f32 v208, v208
    v_exp_f32 v209, v209
    v_smfmac_f32_32x32x32_bf16 v[224:239], v[116:119], v[200:207], v250
    v_exp_f32 v210, v210
    v_exp_f32 v211, v211
    v_exp_f32 v212, v212
    s_waitcnt vmcnt(11)
    v_mfma_f32_32x32x16_bf16 v[192:207], v[32:35], v[240:243], 0
    v_permlane16_swap_b32 v120, v124
    v_permlane16_swap_b32 v121, v125
    v_permlane16_swap_b32 v122, v126
    v_permlane16_swap_b32 v123, v127
    v_exp_f32 v213, v213
    v_exp_f32 v214, v214
    v_exp_f32 v215, v215
    v_exp_f32 v216, v216
    v_exp_f32 v217, v217
    v_exp_f32 v218, v218
    v_exp_f32 v219, v219
    v_exp_f32 v220, v220
    v_exp_f32 v221, v221
    v_exp_f32 v222, v222
    v_smfmac_f32_32x32x32_bf16 v[224:239], v[120:123], v[208:215], v250
    v_exp_f32 v223, v223
    s_add_u32 s62, s60, 14
    s_and_b32 s62, s62, 15
    s_lshl_b32 s62, s62, 11
    s_add_u32 s62, s62, s95
    buffer_load_dwordx4 v[56:59], v255, s[28:31], s62 offen sc1
    buffer_load_dwordx4 v[176:179], v255, s[28:31], s62 offen offset:1024 sc1
    v_exp_f32 v192, v192
    v_exp_f32 v193, v193
    v_smfmac_f32_32x32x32_bf16 v[224:239], v[124:127], v[216:223], v250
    v_exp_f32 v194, v194
    v_exp_f32 v195, v195
    v_exp_f32 v196, v196
    s_waitcnt vmcnt(11)
    v_mfma_f32_32x32x16_bf16 v[208:223], v[36:39], v[240:243], 0
    v_permlane16_swap_b32 v128, v132
    v_permlane16_swap_b32 v129, v133
    v_permlane16_swap_b32 v130, v134
    v_permlane16_swap_b32 v131, v135
    v_exp_f32 v197, v197
    v_exp_f32 v198, v198
    v_exp_f32 v199, v199
    v_exp_f32 v200, v200
    v_exp_f32 v201, v201
    v_exp_f32 v202, v202
    v_exp_f32 v203, v203
    v_exp_f32 v204, v204
    v_exp_f32 v205, v205
    v_exp_f32 v206, v206
    v_smfmac_f32_32x32x32_bf16 v[224:239], v[128:131], v[192:199], v250
    v_exp_f32 v207, v207
    s_add_u32 s62, s60, 15
    s_and_b32 s62, s62, 15
    s_lshl_b32 s62, s62, 11
    s_add_u32 s62, s62, s95
    buffer_load_dwordx4 v[60:63], v255, s[28:31], s62 offen sc1
    buffer_load_dwordx4 v[184:187], v255, s[28:31], s62 offen offset:1024 sc1
    v_exp_f32 v208, v208
    v_exp_f32 v209, v209
    v_smfmac_f32_32x32x32_bf16 v[224:239], v[132:135], v[200:207], v250
    v_exp_f32 v210, v210
    v_exp_f32 v211, v211
    v_exp_f32 v212, v212
    s_waitcnt vmcnt(11)
    v_mfma_f32_32x32x16_bf16 v[192:207], v[40:43], v[240:243], 0
    v_permlane16_swap_b32 v136, v140
    v_permlane16_swap_b32 v137, v141
    v_permlane16_swap_b32 v138, v142
    v_permlane16_swap_b32 v139, v143
    v_exp_f32 v213, v213
    v_exp_f32 v214, v214
    v_exp_f32 v215, v215
    v_exp_f32 v216, v216
    v_exp_f32 v217, v217
    v_exp_f32 v218, v218
    v_exp_f32 v219, v219
    v_exp_f32 v220, v220
    v_exp_f32 v221, v221
    v_exp_f32 v222, v222
    v_smfmac_f32_32x32x32_bf16 v[224:239], v[136:139], v[208:215], v250
    v_exp_f32 v223, v223
    v_exp_f32 v192, v192
    v_exp_f32 v193, v193
    v_smfmac_f32_32x32x32_bf16 v[224:239], v[140:143], v[216:223], v250
    v_exp_f32 v194, v194
    v_exp_f32 v195, v195
    v_exp_f32 v196, v196
    s_waitcnt vmcnt(9)
    v_mfma_f32_32x32x16_bf16 v[208:223], v[44:47], v[240:243], 0
    v_permlane16_swap_b32 v144, v148
    v_permlane16_swap_b32 v145, v149
    v_permlane16_swap_b32 v146, v150
    v_permlane16_swap_b32 v147, v151
    v_exp_f32 v197, v197
    v_exp_f32 v198, v198
    v_exp_f32 v199, v199
    v_exp_f32 v200, v200
    v_exp_f32 v201, v201
    v_exp_f32 v202, v202
    v_exp_f32 v203, v203
    v_exp_f32 v204, v204
    v_exp_f32 v205, v205
    v_exp_f32 v206, v206
    v_smfmac_f32_32x32x32_bf16 v[224:239], v[144:147], v[192:199], v250
    v_exp_f32 v207, v207
    v_exp_f32 v208, v208
    v_exp_f32 v209, v209
    v_smfmac_f32_32x32x32_bf16 v[224:239], v[148:151], v[200:207], v250
    v_exp_f32 v210, v210
    v_exp_f32 v211, v211
    v_exp_f32 v212, v212
    s_waitcnt vmcnt(7)
    v_mfma_f32_32x32x16_bf16 v[192:207], v[48:51], v[240:243], 0
    v_permlane16_swap_b32 v152, v156
    v_permlane16_swap_b32 v153, v157
    v_permlane16_swap_b32 v154, v158
    v_permlane16_swap_b32 v155, v159
    v_exp_f32 v213, v213
    v_exp_f32 v214, v214
    v_exp_f32 v215, v215
    v_exp_f32 v216, v216
    v_exp_f32 v217, v217
    v_exp_f32 v218, v218
    v_exp_f32 v219, v219
    v_exp_f32 v220, v220
    v_exp_f32 v221, v221
    v_exp_f32 v222, v222
    v_smfmac_f32_32x32x32_bf16 v[224:239], v[152:155], v[208:215], v250
    v_exp_f32 v223, v223
    v_exp_f32 v192, v192
    v_exp_f32 v193, v193
    v_smfmac_f32_32x32x32_bf16 v[224:239], v[156:159], v[216:223], v250
    v_exp_f32 v194, v194
    v_exp_f32 v195, v195
    v_exp_f32 v196, v196
    s_waitcnt vmcnt(5)
    v_mfma_f32_32x32x16_bf16 v[208:223], v[52:55], v[240:243], 0
    v_permlane16_swap_b32 v160, v164
    v_permlane16_swap_b32 v161, v165
    v_permlane16_swap_b32 v162, v166
    v_permlane16_swap_b32 v163, v167
    v_exp_f32 v197, v197
    v_exp_f32 v198, v198
    v_exp_f32 v199, v199
    v_exp_f32 v200, v200
    v_exp_f32 v201, v201
    v_exp_f32 v202, v202
    v_exp_f32 v203, v203
    v_exp_f32 v204, v204
    v_exp_f32 v205, v205
    v_exp_f32 v206, v206
    v_smfmac_f32_32x32x32_bf16 v[224:239], v[160:163], v[192:199], v250
    v_exp_f32 v207, v207
    v_exp_f32 v208, v208
    v_exp_f32 v209, v209
    v_smfmac_f32_32x32x32_bf16 v[224:239], v[164:167], v[200:207], v250
    v_exp_f32 v210, v210
    v_exp_f32 v211, v211
    v_exp_f32 v212, v212
    s_waitcnt vmcnt(3)
    v_mfma_f32_32x32x16_bf16 v[192:207], v[56:59], v[240:243], 0
    v_permlane16_swap_b32 v168, v172
    v_permlane16_swap_b32 v169, v173
    v_permlane16_swap_b32 v170, v174
    v_permlane16_swap_b32 v171, v175
    v_exp_f32 v213, v213
    v_exp_f32 v214, v214
    v_exp_f32 v215, v215
    v_exp_f32 v216, v216
    v_exp_f32 v217, v217
    v_exp_f32 v218, v218
    v_exp_f32 v219, v219
    v_exp_f32 v220, v220
    v_exp_f32 v221, v221
    v_exp_f32 v222, v222
    v_smfmac_f32_32x32x32_bf16 v[224:239], v[168:171], v[208:215], v250
    v_exp_f32 v223, v223
    v_exp_f32 v192, v192
    v_exp_f32 v193, v193
    v_smfmac_f32_32x32x32_bf16 v[224:239], v[172:175], v[216:223], v250
    v_exp_f32 v194, v194
    v_exp_f32 v195, v195
    v_exp_f32 v196, v196
    s_waitcnt vmcnt(1)
    v_mfma_f32_32x32x16_bf16 v[208:223], v[60:63], v[240:243], 0
    v_permlane16_swap_b32 v176, v180
    v_permlane16_swap_b32 v177, v181
    v_permlane16_swap_b32 v178, v182
    v_permlane16_swap_b32 v179, v183
    ds_read_b128 v[240:243], v246 offset:1024
    v_add_u32 v246, 1024, v246
    v_exp_f32 v197, v197
    v_exp_f32 v198, v198
    v_exp_f32 v199, v199
    v_exp_f32 v200, v200
    v_exp_f32 v201, v201
    v_exp_f32 v202, v202
    v_exp_f32 v203, v203
    v_exp_f32 v204, v204
    v_exp_f32 v205, v205
    v_exp_f32 v206, v206
    v_smfmac_f32_32x32x32_bf16 v[224:239], v[176:179], v[192:199], v250
    v_exp_f32 v207, v207
    v_exp_f32 v208, v208
    v_exp_f32 v209, v209
    v_smfmac_f32_32x32x32_bf16 v[224:239], v[180:183], v[200:207], v250
    v_exp_f32 v210, v210
    v_exp_f32 v211, v211
    v_exp_f32 v212, v212
    s_waitcnt lgkmcnt(0)
    v_mfma_f32_32x32x16_bf16 v[192:207], v[0:3], v[240:243], 0
    s_waitcnt vmcnt(0)
    v_permlane16_swap_b32 v184, v188
    v_permlane16_swap_b32 v185, v189
    v_permlane16_swap_b32 v186, v190
    v_permlane16_swap_b32 v187, v191
    v_exp_f32 v213, v213
    v_exp_f32 v214, v214
    v_exp_f32 v215, v215
    v_exp_f32 v216, v216
    v_exp_f32 v217, v217
    v_exp_f32 v218, v218
    v_exp_f32 v219, v219
    v_exp_f32 v220, v220
    v_exp_f32 v221, v221
    v_exp_f32 v222, v222
    v_smfmac_f32_32x32x32_bf16 v[224:239], v[184:187], v[208:215], v250
    v_exp_f32 v223, v223
.p2alignl 6, 0xbf800000
fk_att_loop:
    v_exp_f32 v192, v192
    v_exp_f32 v193, v193
    v_smfmac_f32_32x32x32_bf16 v[224:239], v[188:191], v[216:223], v250
    v_exp_f32 v194, v194
    v_exp_f32 v195, v195
    v_exp_f32 v196, v196
    v_mfma_f32_32x32x16_bf16 v[208:223], v[4:7], v[240:243], 0
    v_exp_f32 v197, v197
    v_exp_f32 v198, v198
    v_exp_f32 v199, v199
    v_exp_f32 v200, v200
    v_exp_f32 v201, v201
    v_exp_f32 v202, v202
    v_exp_f32 v203, v203
    v_exp_f32 v204, v204
    ds_write_b128 v244, v[224:227]
    ds_write_b128 v244, v[228:231] offset:1024
    ds_write_b32 v245, v232 offset:2048
    ds_write_b32 v253, v246
    v_mfma_f32_32x32x8_bf16 v[224:239], v[248:249], v[248:249], 0
    v_add_u32 v244, 9216, v244
    v_add_u32 v245, 9216, v245
    v_exp_f32 v205, v205
    v_exp_f32 v206, v206
    v_smfmac_f32_32x32x32_bf16 v[224:239], v[64:67], v[192:199], v250
    v_exp_f32 v207, v207
    v_exp_f32 v208, v208
    v_exp_f32 v209, v209
    v_smfmac_f32_32x32x32_bf16 v[224:239], v[68:71], v[200:207], v250
    v_exp_f32 v210, v210
    v_exp_f32 v211, v211
    v_exp_f32 v212, v212
    v_mfma_f32_32x32x16_bf16 v[192:207], v[8:11], v[240:243], 0
    v_exp_f32 v213, v213
    v_exp_f32 v214, v214
    v_exp_f32 v215, v215
    v_exp_f32 v216, v216
    v_exp_f32 v217, v217
    v_exp_f32 v218, v218
    v_exp_f32 v219, v219
    v_exp_f32 v220, v220
    v_exp_f32 v221, v221
    v_exp_f32 v222, v222
    v_smfmac_f32_32x32x32_bf16 v[224:239], v[72:75], v[208:215], v250
    v_exp_f32 v223, v223
    v_exp_f32 v192, v192
    v_exp_f32 v193, v193
    v_smfmac_f32_32x32x32_bf16 v[224:239], v[76:79], v[216:223], v250
    v_exp_f32 v194, v194
    v_exp_f32 v195, v195
    v_exp_f32 v196, v196
    v_mfma_f32_32x32x16_bf16 v[208:223], v[12:15], v[240:243], 0
    v_exp_f32 v197, v197
    v_exp_f32 v198, v198
    v_exp_f32 v199, v199
    v_exp_f32 v200, v200
    v_exp_f32 v201, v201
    v_exp_f32 v202, v202
    v_exp_f32 v203, v203
    v_exp_f32 v204, v204
    v_exp_f32 v205, v205
    v_exp_f32 v206, v206
    v_smfmac_f32_32x32x32_bf16 v[224:239], v[80:83], v[192:199], v250
    v_exp_f32 v207, v207
    v_exp_f32 v208, v208
    v_exp_f32 v209, v209
    v_smfmac_f32_32x32x32_bf16 v[224:239], v[84:87], v[200:207], v250
    v_exp_f32 v210, v210
    v_exp_f32 v211, v211
    v_exp_f32 v212, v212
    v_mfma_f32_32x32x16_bf16 v[192:207], v[16:19], v[240:243], 0
    v_exp_f32 v213, v213
    v_exp_f32 v214, v214
    v_exp_f32 v215, v215
    v_exp_f32 v216, v216
    v_exp_f32 v217, v217
    v_exp_f32 v218, v218
    v_exp_f32 v219, v219
    v_exp_f32 v220, v220
    v_exp_f32 v221, v221
    v_exp_f32 v222, v222
    v_smfmac_f32_32x32x32_bf16 v[224:239], v[88:91], v[208:215], v250
    v_exp_f32 v223, v223
    v_exp_f32 v192, v192
    v_exp_f32 v193, v193
    v_smfmac_f32_32x32x32_bf16 v[224:239], v[92:95], v[216:223], v250
    v_exp_f32 v194, v194
    v_exp_f32 v195, v195
    v_exp_f32 v196, v196
    v_mfma_f32_32x32x16_bf16 v[208:223], v[20:23], v[240:243], 0
    v_exp_f32 v197, v197
    v_exp_f32 v198, v198
    v_exp_f32 v199, v199
    v_exp_f32 v200, v200
    v_exp_f32 v201, v201
    v_exp_f32 v202, v202
    v_exp_f32 v203, v203
    v_exp_f32 v204, v204
    v_exp_f32 v205, v205
    v_exp_f32 v206, v206
    v_smfmac_f32_32x32x32_bf16 v[224:239], v[96:99], v[192:199], v250
    v_exp_f32 v207, v207
    v_exp_f32 v208, v208
    v_exp_f32 v209, v209
    v_smfmac_f32_32x32x32_bf16 v[224:239], v[100:103], v[200:207], v250
    v_exp_f32 v210, v210
    v_exp_f32 v211, v211
    v_exp_f32 v212, v212
    v_mfma_f32_32x32x16_bf16 v[192:207], v[24:27], v[240:243], 0
    v_exp_f32 v213, v213
    v_exp_f32 v214, v214
    v_exp_f32 v215, v215
    v_exp_f32 v216, v216
    v_exp_f32 v217, v217
    v_exp_f32 v218, v218
    v_exp_f32 v219, v219
    v_exp_f32 v220, v220
    v_exp_f32 v221, v221
    v_exp_f32 v222, v222
    v_smfmac_f32_32x32x32_bf16 v[224:239], v[104:107], v[208:215], v250
    v_exp_f32 v223, v223
    v_exp_f32 v192, v192
    v_exp_f32 v193, v193
    v_smfmac_f32_32x32x32_bf16 v[224:239], v[108:111], v[216:223], v250
    v_exp_f32 v194, v194
    v_exp_f32 v195, v195
    v_exp_f32 v196, v196
    v_mfma_f32_32x32x16_bf16 v[208:223], v[28:31], v[240:243], 0
    v_exp_f32 v197, v197
    v_exp_f32 v198, v198
    v_exp_f32 v199, v199
    v_exp_f32 v200, v200
    v_exp_f32 v201, v201
    v_exp_f32 v202, v202
    v_exp_f32 v203, v203
    v_exp_f32 v204, v204
    v_exp_f32 v205, v205
    v_exp_f32 v206, v206
    v_smfmac_f32_32x32x32_bf16 v[224:239], v[112:115], v[192:199], v250
    v_exp_f32 v207, v207
    v_exp_f32 v208, v208
    v_exp_f32 v209, v209
    v_smfmac_f32_32x32x32_bf16 v[224:239], v[116:119], v[200:207], v250
    v_exp_f32 v210, v210
    v_exp_f32 v211, v211
    v_exp_f32 v212, v212
    v_mfma_f32_32x32x16_bf16 v[192:207], v[32:35], v[240:243], 0
    v_exp_f32 v213, v213
    v_exp_f32 v214, v214
    v_exp_f32 v215, v215
    v_exp_f32 v216, v216
    v_exp_f32 v217, v217
    v_exp_f32 v218, v218
    v_exp_f32 v219, v219
    v_exp_f32 v220, v220
    v_exp_f32 v221, v221
    v_exp_f32 v222, v222
    v_smfmac_f32_32x32x32_bf16 v[224:239], v[120:123], v[208:215], v250
    v_exp_f32 v223, v223
    v_exp_f32 v192, v192
    v_exp_f32 v193, v193
    v_smfmac_f32_32x32x32_bf16 v[224:239], v[124:127], v[216:223], v250
    v_exp_f32 v194, v194
    v_exp_f32 v195, v195
    v_exp_f32 v196, v196
    v_mfma_f32_32x32x16_bf16 v[208:223], v[36:39], v[240:243], 0
    v_exp_f32 v197, v197
    v_exp_f32 v198, v198
    v_exp_f32 v199, v199
    v_exp_f32 v200, v200
    v_exp_f32 v201, v201
    v_exp_f32 v202, v202
    v_exp_f32 v203, v203
    v_exp_f32 v204, v204
    v_exp_f32 v205, v205
    v_exp_f32 v206, v206
    v_smfmac_f32_32x32x32_bf16 v[224:239], v[128:131], v[192:199], v250
    v_exp_f32 v207, v207
    v_exp_f32 v208, v208
    v_exp_f32 v209, v209
    v_smfmac_f32_32x32x32_bf16 v[224:239], v[132:135], v[200:207], v250
    v_exp_f32 v210, v210
    v_exp_f32 v211, v211
    v_exp_f32 v212, v212
    v_mfma_f32_32x32x16_bf16 v[192:207], v[40:43], v[240:243], 0
    v_exp_f32 v213, v213
    v_exp_f32 v214, v214
    v_exp_f32 v215, v215
    v_exp_f32 v216, v216
    v_exp_f32 v217, v217
    v_exp_f32 v218, v218
    v_exp_f32 v219, v219
    v_exp_f32 v220, v220
    v_exp_f32 v221, v221
    v_exp_f32 v222, v222
    v_smfmac_f32_32x32x32_bf16 v[224:239], v[136:139], v[208:215], v250
    v_exp_f32 v223, v223
    v_exp_f32 v192, v192
    v_exp_f32 v193, v193
    v_smfmac_f32_32x32x32_bf16 v[224:239], v[140:143], v[216:223], v250
    v_exp_f32 v194, v194
    v_exp_f32 v195, v195
    v_exp_f32 v196, v196
    v_mfma_f32_32x32x16_bf16 v[208:223], v[44:47], v[240:243], 0
    v_exp_f32 v197, v197
    v_exp_f32 v198, v198
    v_exp_f32 v199, v199
    v_exp_f32 v200, v200
    v_exp_f32 v201, v201
    v_exp_f32 v202, v202
    v_exp_f32 v203, v203
    v_exp_f32 v204, v204
    v_exp_f32 v205, v205
    v_exp_f32 v206, v206
    v_smfmac_f32_32x32x32_bf16 v[224:239], v[144:147], v[192:199], v250
    v_exp_f32 v207, v207
    v_exp_f32 v208, v208
    v_exp_f32 v209, v209
    v_smfmac_f32_32x32x32_bf16 v[224:239], v[148:151], v[200:207], v250
    v_exp_f32 v210, v210
    v_exp_f32 v211, v211
    v_exp_f32 v212, v212
    v_mfma_f32_32x32x16_bf16 v[192:207], v[48:51], v[240:243], 0
    v_exp_f32 v213, v213
    v_exp_f32 v214, v214
    v_exp_f32 v215, v215
    v_exp_f32 v216, v216
    v_exp_f32 v217, v217
    v_exp_f32 v218, v218
    v_exp_f32 v219, v219
    v_exp_f32 v220, v220
    v_exp_f32 v221, v221
    v_exp_f32 v222, v222
    v_smfmac_f32_32x32x32_bf16 v[224:239], v[152:155], v[208:215], v250
    v_exp_f32 v223, v223
    v_exp_f32 v192, v192
    v_exp_f32 v193, v193
    v_smfmac_f32_32x32x32_bf16 v[224:239], v[156:159], v[216:223], v250
    v_exp_f32 v194, v194
    v_exp_f32 v195, v195
    v_exp_f32 v196, v196
    v_mfma_f32_32x32x16_bf16 v[208:223], v[52:55], v[240:243], 0
    v_exp_f32 v197, v197
    v_exp_f32 v198, v198
    v_exp_f32 v199, v199
    v_exp_f32 v200, v200
    v_exp_f32 v201, v201
    v_exp_f32 v202, v202
    v_exp_f32 v203, v203
    v_exp_f32 v204, v204
    v_exp_f32 v205, v205
    v_exp_f32 v206, v206
    v_smfmac_f32_32x32x32_bf16 v[224:239], v[160:163], v[192:199], v250
    v_exp_f32 v207, v207
    v_exp_f32 v208, v208
    v_exp_f32 v209, v209
    v_smfmac_f32_32x32x32_bf16 v[224:239], v[164:167], v[200:207], v250
    v_exp_f32 v210, v210
    v_exp_f32 v211, v211
    v_exp_f32 v212, v212
    v_mfma_f32_32x32x16_bf16 v[192:207], v[56:59], v[240:243], 0
    v_exp_f32 v213, v213
    v_exp_f32 v214, v214
    v_exp_f32 v215, v215
    v_exp_f32 v216, v216
    v_exp_f32 v217, v217
    v_exp_f32 v218, v218
    v_exp_f32 v219, v219
    v_exp_f32 v220, v220
    v_exp_f32 v221, v221
    v_exp_f32 v222, v222
    v_smfmac_f32_32x32x32_bf16 v[224:239], v[168:171], v[208:215], v250
    v_exp_f32 v223, v223
    v_exp_f32 v192, v192
    v_exp_f32 v193, v193
    v_smfmac_f32_32x32x32_bf16 v[224:239], v[172:175], v[216:223], v250
    v_exp_f32 v194, v194
    v_exp_f32 v195, v195
    v_exp_f32 v196, v196
    v_mfma_f32_32x32x16_bf16 v[208:223], v[60:63], v[240:243], 0
    ds_read_b128 v[240:243], v246 offset:1024
    v_add_u32 v246, 1024, v246
    v_exp_f32 v197, v197
    v_exp_f32 v198, v198
    v_exp_f32 v199, v199
    v_exp_f32 v200, v200
    v_exp_f32 v201, v201
    v_exp_f32 v202, v202
    v_exp_f32 v203, v203
    v_exp_f32 v204, v204
    v_exp_f32 v205, v205
    v_exp_f32 v206, v206
    v_smfmac_f32_32x32x32_bf16 v[224:239], v[176:179], v[192:199], v250
    v_exp_f32 v207, v207
    v_exp_f32 v208, v208
    v_exp_f32 v209, v209
    v_smfmac_f32_32x32x32_bf16 v[224:239], v[180:183], v[200:207], v250
    v_exp_f32 v210, v210
    v_exp_f32 v211, v211
    v_exp_f32 v212, v212
    s_waitcnt lgkmcnt(0)
    v_mfma_f32_32x32x16_bf16 v[192:207], v[0:3], v[240:243], 0
    v_exp_f32 v213, v213
    v_exp_f32 v214, v214
    v_exp_f32 v215, v215
    v_exp_f32 v216, v216
    v_exp_f32 v217, v217
    v_exp_f32 v218, v218
    v_exp_f32 v219, v219
    v_exp_f32 v220, v220
    v_exp_f32 v221, v221
    v_exp_f32 v222, v222
    v_smfmac_f32_32x32x32_bf16 v[224:239], v[184:187], v[208:215], v250
    v_exp_f32 v223, v223
    s_sub_u32 s94, s94, 1
    s_cmp_lg_u32 s94, 0
    s_cbranch_scc1 fk_att_loop
    v_smfmac_f32_32x32x32_bf16 v[224:239], v[188:191], v[216:223], v250
    s_add_u32 s7, s56, 4
    v_lshrrev_b32 v96, 3, v254
    v_and_b32 v97, 7, v254
    v_bfe_u32 v98, v254, 4, 1
    v_lshlrev_b32 v98, 2, v98
    v_xor_b32 v97, v97, v98
    v_lshlrev_b32 v102, 10, v96
    v_lshl_add_u32 v102, v97, 4, v102
    s_nop 2
    v_add_u32 v247, 4, v251
    ds_write_b128 v244, v[224:227]
    ds_write_b128 v244, v[228:231] offset:1024
    ds_write_b32 v245, v232 offset:2048
    ds_write_b32 v253, v246
fk_lw_72:
    ds_read_b32 v98, v247
    s_waitcnt lgkmcnt(0)
    v_readfirstlane_b32 s97, v98
    s_cmp_ge_u32 s97, 6
    s_cbranch_scc1 fk_lwk_73
    s_sleep 1
    s_branch fk_lw_72
fk_lwk_73:
    s_setprio 3
    s_add_u32 s62, s20, 0
    buffer_load_dwordx4 v[168:171], v255, s[28:31], s62 offen offset:0 sc1
    buffer_load_dwordx4 v[172:175], v255, s[28:31], s62 offen offset:1024 sc1
    buffer_load_dwordx4 v[176:179], v255, s[28:31], s62 offen offset:2048 sc1
    buffer_load_dwordx4 v[180:183], v255, s[28:31], s62 offen offset:3072 sc1
    s_add_u32 s62, s20, 8192
    buffer_load_dwordx4 v[184:187], v255, s[28:31], s62 offen offset:0 sc1
    buffer_load_dwordx4 v[188:191], v255, s[28:31], s62 offen offset:1024 sc1
    buffer_load_dwordx4 v[192:195], v255, s[28:31], s62 offen offset:2048 sc1
    buffer_load_dwordx4 v[196:199], v255, s[28:31], s62 offen offset:3072 sc1
    s_add_u32 s62, s20, 16384
    buffer_load_dwordx4 v[200:203], v255, s[28:31], s62 offen offset:0 sc1
    buffer_load_dwordx4 v[204:207], v255, s[28:31], s62 offen offset:1024 sc1
    buffer_load_dwordx4 v[208:211], v255, s[28:31], s62 offen offset:2048 sc1
    buffer_load_dwordx4 v[212:215], v255, s[28:31], s62 offen offset:3072 sc1
    s_add_u32 s62, s20, 24576
    buffer_load_dwordx4 v[216:219], v255, s[28:31], s62 offen offset:0 sc1
    buffer_load_dwordx4 v[220:223], v255, s[28:31], s62 offen offset:1024 sc1
    buffer_load_dwordx4 v[224:227], v255, s[28:31], s62 offen offset:2048 sc1
    buffer_load_dwordx4 v[228:231], v255, s[28:31], s62 offen offset:3072 sc1
    s_call_b64 s[8:9], fk_finalize
    s_add_u32 m0, s18, 36864
    s_add_u32 s63, s19, 65536
fk_wodma:
    buffer_load_dwordx4 v102, s[48:51], s19 offen lds
    s_add_u32 s19, s19, 8192
    s_add_u32 m0, m0, 1024
    s_cmp_lt_u32 s19, s63
    s_cbranch_scc1 fk_wodma
    v_lshrrev_b32 v96, 5, v254
    v_bfe_u32 v97, v254, 2, 2
    v_lshl_add_u32 v96, v96, 2, v97
    v_lshlrev_b32 v100, 7, v96
    v_and_b32 v96, 1, v254
    v_lshl_add_u32 v100, v96, 5, v100
    v_bfe_u32 v96, v254, 4, 1
    v_lshl_add_u32 v100, v96, 4, v100
    v_bfe_u32 v96, v254, 1, 1
    v_lshl_add_u32 v100, v96, 3, v100
    v_bfe_u32 v96, v254, 3, 1
    s_lshr_b32 s62, s56, 1
    v_xor_b32 v96, s62, v96
    v_lshl_add_u32 v100, v96, 6, v100
    v_add_u32 v101, 36864, v100
    ds_read_b64_tr_b16 v[104:105], v100 offset:0
    ds_read_b64_tr_b16 v[106:107], v100 offset:1024
    ds_read_b64_tr_b16 v[108:109], v100 offset:2048
    ds_read_b64_tr_b16 v[110:111], v100 offset:3072
    ds_read_b64_tr_b16 v[112:113], v100 offset:4096
    ds_read_b64_tr_b16 v[114:115], v100 offset:5120
    ds_read_b64_tr_b16 v[116:117], v100 offset:6144
    ds_read_b64_tr_b16 v[118:119], v100 offset:7168
    s_waitcnt lgkmcnt(6)
    ds_read_b64_tr_b16 v[120:121], v100 offset:9216
    ds_read_b64_tr_b16 v[122:123], v100 offset:10240
    ds_read_b64_tr_b16 v[124:125], v100 offset:11264
    ds_read_b64_tr_b16 v[126:127], v100 offset:12288
    ds_read_b64_tr_b16 v[128:129], v100 offset:13312
    ds_read_b64_tr_b16 v[130:131], v100 offset:14336
    ds_read_b64_tr_b16 v[132:133], v100 offset:15360
    ds_read_b64_tr_b16 v[134:135], v100 offset:16384
    s_waitcnt lgkmcnt(6)
    ds_read_b64_tr_b16 v[136:137], v100 offset:18432
    ds_read_b64_tr_b16 v[138:139], v100 offset:19456
    ds_read_b64_tr_b16 v[140:141], v100 offset:20480
    ds_read_b64_tr_b16 v[142:143], v100 offset:21504
    ds_read_b64_tr_b16 v[144:145], v100 offset:22528
    ds_read_b64_tr_b16 v[146:147], v100 offset:23552
    ds_read_b64_tr_b16 v[148:149], v100 offset:24576
    ds_read_b64_tr_b16 v[150:151], v100 offset:25600
    s_waitcnt lgkmcnt(6)
    ds_read_b64_tr_b16 v[152:153], v100 offset:27648
    ds_read_b64_tr_b16 v[154:155], v100 offset:28672
    ds_read_b64_tr_b16 v[156:157], v100 offset:29696
    ds_read_b64_tr_b16 v[158:159], v100 offset:30720
    ds_read_b64_tr_b16 v[160:161], v100 offset:31744
    ds_read_b64_tr_b16 v[162:163], v100 offset:32768
    ds_read_b64_tr_b16 v[164:165], v100 offset:33792
    ds_read_b64_tr_b16 v[166:167], v100 offset:34816
    v_and_b32 v24, 31, v254
    v_lshlrev_b32 v24, 10, v24
    v_lshrrev_b32 v96, 5, v254
    v_lshl_add_u32 v24, v96, 5, v24
    buffer_load_dwordx4 v[16:19], v24, s[44:47], s21 offen
    buffer_load_dwordx4 v[20:23], v24, s[44:47], s21 offen offset:16
    s_waitcnt vmcnt(11) lgkmcnt(0)
    v_mfma_f32_32x32x16_bf16 v[0:15], v[104:107], v[168:171], 0
    v_mfma_f32_32x32x16_bf16 v[0:15], v[108:111], v[172:175], v[0:15]
    v_mfma_f32_32x32x16_bf16 v[0:15], v[112:115], v[176:179], v[0:15]
    v_mfma_f32_32x32x16_bf16 v[0:15], v[116:119], v[180:183], v[0:15]
    v_mfma_f32_32x32x16_bf16 v[0:15], v[120:123], v[184:187], v[0:15]
    v_mfma_f32_32x32x16_bf16 v[0:15], v[124:127], v[188:191], v[0:15]
    v_mfma_f32_32x32x16_bf16 v[0:15], v[128:131], v[192:195], v[0:15]
    v_mfma_f32_32x32x16_bf16 v[0:15], v[132:135], v[196:199], v[0:15]
    s_waitcnt vmcnt(2)
    s_mov_b64 exec, 1
    ds_add_u32 v251, v252
    s_mov_b64 exec, -1
    v_mfma_f32_32x32x16_bf16 v[0:15], v[136:139], v[200:203], v[0:15]
    v_mfma_f32_32x32x16_bf16 v[0:15], v[140:143], v[204:207], v[0:15]
    v_mfma_f32_32x32x16_bf16 v[0:15], v[144:147], v[208:211], v[0:15]
    v_mfma_f32_32x32x16_bf16 v[0:15], v[148:151], v[212:215], v[0:15]
    v_mfma_f32_32x32x16_bf16 v[0:15], v[152:155], v[216:219], v[0:15]
    v_mfma_f32_32x32x16_bf16 v[0:15], v[156:159], v[220:223], v[0:15]
    v_mfma_f32_32x32x16_bf16 v[0:15], v[160:163], v[224:227], v[0:15]
    v_mfma_f32_32x32x16_bf16 v[0:15], v[164:167], v[228:231], v[0:15]
    ds_read_b32 v98, v251
    s_waitcnt lgkmcnt(0)
fk_sbr_74:
    v_readfirstlane_b32 s97, v98
    s_cmp_ge_u32 s97, 20
    s_cbranch_scc1 fk_sbk_75
    ds_read_b32 v98, v251
    s_waitcnt lgkmcnt(0)
    s_branch fk_sbr_74
fk_sbk_75:
    s_mov_b32 s94, 0
fk_opoll:
    s_add_u32 s62, s20, 4096
    buffer_load_dwordx4 v[168:171], v255, s[28:31], s62 offen offset:0 sc1
    buffer_load_dwordx4 v[172:175], v255, s[28:31], s62 offen offset:1024 sc1
    buffer_load_dwordx4 v[176:179], v255, s[28:31], s62 offen offset:2048 sc1
    buffer_load_dwordx4 v[180:183], v255, s[28:31], s62 offen offset:3072 sc1
    s_add_u32 s62, s20, 12288
    buffer_load_dwordx4 v[184:187], v255, s[28:31], s62 offen offset:0 sc1
    buffer_load_dwordx4 v[188:191], v255, s[28:31], s62 offen offset:1024 sc1
    buffer_load_dwordx4 v[192:195], v255, s[28:31], s62 offen offset:2048 sc1
    buffer_load_dwordx4 v[196:199], v255, s[28:31], s62 offen offset:3072 sc1
    s_add_u32 s62, s20, 20480
    buffer_load_dwordx4 v[200:203], v255, s[28:31], s62 offen offset:0 sc1
    buffer_load_dwordx4 v[204:207], v255, s[28:31], s62 offen offset:1024 sc1
    buffer_load_dwordx4 v[208:211], v255, s[28:31], s62 offen offset:2048 sc1
    buffer_load_dwordx4 v[212:215], v255, s[28:31], s62 offen offset:3072 sc1
    s_add_u32 s62, s20, 28672
    buffer_load_dwordx4 v[216:219], v255, s[28:31], s62 offen offset:0 sc1
    buffer_load_dwordx4 v[220:223], v255, s[28:31], s62 offen offset:1024 sc1
    buffer_load_dwordx4 v[224:227], v255, s[28:31], s62 offen offset:2048 sc1
    buffer_load_dwordx4 v[228:231], v255, s[28:31], s62 offen offset:3072 sc1
    ds_read_b64_tr_b16 v[104:105], v101 offset:0
    ds_read_b64_tr_b16 v[106:107], v101 offset:1024
    ds_read_b64_tr_b16 v[108:109], v101 offset:2048
    ds_read_b64_tr_b16 v[110:111], v101 offset:3072
    ds_read_b64_tr_b16 v[112:113], v101 offset:4096
    ds_read_b64_tr_b16 v[114:115], v101 offset:5120
    ds_read_b64_tr_b16 v[116:117], v101 offset:6144
    ds_read_b64_tr_b16 v[118:119], v101 offset:7168
    s_waitcnt lgkmcnt(6)
    ds_read_b64_tr_b16 v[120:121], v101 offset:9216
    ds_read_b64_tr_b16 v[122:123], v101 offset:10240
    ds_read_b64_tr_b16 v[124:125], v101 offset:11264
    ds_read_b64_tr_b16 v[126:127], v101 offset:12288
    ds_read_b64_tr_b16 v[128:129], v101 offset:13312
    ds_read_b64_tr_b16 v[130:131], v101 offset:14336
    ds_read_b64_tr_b16 v[132:133], v101 offset:15360
    ds_read_b64_tr_b16 v[134:135], v101 offset:16384
    s_waitcnt lgkmcnt(6)
    ds_read_b64_tr_b16 v[136:137], v101 offset:18432
    ds_read_b64_tr_b16 v[138:139], v101 offset:19456
    ds_read_b64_tr_b16 v[140:141], v101 offset:20480
    ds_read_b64_tr_b16 v[142:143], v101 offset:21504
    ds_read_b64_tr_b16 v[144:145], v101 offset:22528
    ds_read_b64_tr_b16 v[146:147], v101 offset:23552
    ds_read_b64_tr_b16 v[148:149], v101 offset:24576
    ds_read_b64_tr_b16 v[150:151], v101 offset:25600
    s_waitcnt lgkmcnt(6)
    ds_read_b64_tr_b16 v[152:153], v101 offset:27648
    ds_read_b64_tr_b16 v[154:155], v101 offset:28672
    ds_read_b64_tr_b16 v[156:157], v101 offset:29696
    ds_read_b64_tr_b16 v[158:159], v101 offset:30720
    ds_read_b64_tr_b16 v[160:161], v101 offset:31744
    ds_read_b64_tr_b16 v[162:163], v101 offset:32768
    ds_read_b64_tr_b16 v[164:165], v101 offset:33792
    ds_read_b64_tr_b16 v[166:167], v101 offset:34816
    s_waitcnt vmcnt(12)
    v_max3_u32 v64, v168, v169, v170
    v_max3_u32 v72, v171, v172, v173
    v_max3_u32 v65, v176, v177, v178
    v_max3_u32 v73, v179, v180, v181
    v_max3_u32 v64, v174, v175, v64
    v_max3_u32 v65, v182, v183, v65
    s_waitcnt vmcnt(8)
    v_max3_u32 v66, v184, v185, v186
    v_max3_u32 v74, v187, v188, v189
    v_max3_u32 v67, v192, v193, v194
    v_max3_u32 v75, v195, v196, v197
    v_max3_u32 v66, v190, v191, v66
    v_max3_u32 v67, v198, v199, v67
    s_waitcnt vmcnt(4)
    v_max3_u32 v68, v200, v201, v202
    v_max3_u32 v76, v203, v204, v205
    v_max3_u32 v69, v208, v209, v210
    v_max3_u32 v77, v211, v212, v213
    v_max3_u32 v68, v206, v207, v68
    v_max3_u32 v69, v214, v215, v69
    s_waitcnt vmcnt(0)
    v_max3_u32 v70, v216, v217, v218
    v_max3_u32 v78, v219, v220, v221
    v_max3_u32 v71, v224, v225, v226
    v_max3_u32 v79, v227, v228, v229
    v_max3_u32 v70, v222, v223, v70
    v_max3_u32 v71, v230, v231, v71
    v_max3_u32 v64, v64, v65, v66
    v_max3_u32 v67, v67, v68, v69
    v_max3_u32 v70, v70, v71, v72
    v_max3_u32 v73, v73, v74, v75
    v_max3_u32 v76, v76, v77, v78
    v_max3_u32 v64, v64, v67, v70
    v_max3_u32 v73, v73, v76, v79
    v_max_u32 v64, v64, v73
    v_cmp_eq_u32 vcc, -1, v64
    s_waitcnt lgkmcnt(0)
    s_cmp_eq_u64 vcc, 0
    s_cbranch_scc1 fk_opoll_ok
    s_add_u32 s94, s94, 1
    s_cmp_lt_u32 s94, 32768
    s_cbranch_scc1 fk_opoll
fk_opoll_ok:
    v_mfma_f32_32x32x16_bf16 v[0:15], v[104:107], v[168:171], v[0:15]
    v_lshlrev_b32 v32, 16, v16
    v_mfma_f32_32x32x16_bf16 v[0:15], v[108:111], v[172:175], v[0:15]
    v_and_b32 v33, 0xffff0000, v16
    v_mfma_f32_32x32x16_bf16 v[0:15], v[112:115], v[176:179], v[0:15]
    v_lshlrev_b32 v34, 16, v17
    v_mfma_f32_32x32x16_bf16 v[0:15], v[116:119], v[180:183], v[0:15]
    v_and_b32 v35, 0xffff0000, v17
    v_mfma_f32_32x32x16_bf16 v[0:15], v[120:123], v[184:187], v[0:15]
    v_lshlrev_b32 v36, 16, v18
    v_mfma_f32_32x32x16_bf16 v[0:15], v[124:127], v[188:191], v[0:15]
    v_and_b32 v37, 0xffff0000, v18
    v_mfma_f32_32x32x16_bf16 v[0:15], v[128:131], v[192:195], v[0:15]
    v_lshlrev_b32 v38, 16, v19
    v_mfma_f32_32x32x16_bf16 v[0:15], v[132:135], v[196:199], v[0:15]
    v_and_b32 v39, 0xffff0000, v19
    v_mfma_f32_32x32x16_bf16 v[0:15], v[136:139], v[200:203], v[0:15]
    v_lshlrev_b32 v40, 16, v20
    v_mfma_f32_32x32x16_bf16 v[0:15], v[140:143], v[204:207], v[0:15]
    v_and_b32 v41, 0xffff0000, v20
    v_mfma_f32_32x32x16_bf16 v[0:15], v[144:147], v[208:211], v[0:15]
    v_lshlrev_b32 v42, 16, v21
    v_mfma_f32_32x32x16_bf16 v[0:15], v[148:151], v[212:215], v[0:15]
    v_and_b32 v43, 0xffff0000, v21
    v_mfma_f32_32x32x16_bf16 v[0:15], v[152:155], v[216:219], v[0:15]
    v_lshlrev_b32 v44, 16, v22
    v_mfma_f32_32x32x16_bf16 v[0:15], v[156:159], v[220:223], v[0:15]
    v_and_b32 v45, 0xffff0000, v22
    v_mfma_f32_32x32x16_bf16 v[0:15], v[160:163], v[224:227], v[0:15]
    v_lshlrev_b32 v46, 16, v23
    v_mfma_f32_32x32x16_bf16 v[0:15], v[164:167], v[228:231], v[0:15]
    v_and_b32 v47, 0xffff0000, v23
    s_mul_i32 s62, s56, 18432
    s_add_u32 s62, s62, 86016
    v_add_u32 v96, s62, v255
fk_lw_76:
    ds_read_b32 v98, v247
    s_waitcnt lgkmcnt(0)
    v_readfirstlane_b32 s97, v98
    s_cmp_ge_u32 s97, 10
    s_cbranch_scc1 fk_lwk_77
    s_branch fk_lw_76
fk_lwk_77:
    ds_read_b128 v[48:51], v96 offset:0
    ds_read_b128 v[52:55], v96 offset:1024
    ds_read_b128 v[56:59], v96 offset:2048
    ds_read_b128 v[60:63], v96 offset:3072
    s_waitcnt lgkmcnt(0)
    v_pk_fma_f32 v[32:33], v[0:1], v[48:49], v[32:33]
    v_pk_fma_f32 v[34:35], v[2:3], v[50:51], v[34:35]
    v_pk_fma_f32 v[36:37], v[4:5], v[52:53], v[36:37]
    v_pk_fma_f32 v[38:39], v[6:7], v[54:55], v[38:39]
    v_pk_fma_f32 v[40:41], v[8:9], v[56:57], v[40:41]
    v_pk_fma_f32 v[42:43], v[10:11], v[58:59], v[42:43]
    v_pk_fma_f32 v[44:45], v[12:13], v[60:61], v[44:45]
    v_pk_fma_f32 v[46:47], v[14:15], v[62:63], v[46:47]
    v_cvt_pk_bf16_f32 v16, v32, v33
    v_cvt_pk_bf16_f32 v17, v34, v35
    v_cvt_pk_bf16_f32 v18, v36, v37
    v_cvt_pk_bf16_f32 v19, v38, v39
    v_cvt_pk_bf16_f32 v20, v40, v41
    v_cvt_pk_bf16_f32 v21, v42, v43
    v_cvt_pk_bf16_f32 v22, v44, v45
    v_cvt_pk_bf16_f32 v23, v46, v47
    buffer_store_dwordx4 v[16:19], v24, s[52:55], s21 offen nt
    buffer_store_dwordx4 v[20:23], v24, s[52:55], s21 offen offset:16 nt
fk_q_end:
    s_endpgm
fk_end:
    s_endpgm
.section .rodata,"a"
.p2align 6
.amdhsa_kernel recurrent_scan__grouped_kv_mqa__geglu_ffn__prompt_kernel
  .amdhsa_next_free_vgpr 256
  .amdhsa_next_free_sgpr 102
  .amdhsa_accum_offset 256
  .amdhsa_group_segment_fixed_size 0
  .amdhsa_kernarg_size 96
  .amdhsa_user_sgpr_count 2
  .amdhsa_user_sgpr_kernarg_segment_ptr 1
  .amdhsa_system_sgpr_workgroup_id_x 1
.end_amdhsa_kernel
```
